```python
import torch

def _softmax(x, axis=-1):
    return torch.softmax(x, dim=axis)
def _gelu(x):
    return torch.nn.functional.gelu(x, approximate="tanh")
def _silu(x):
    return torch.nn.functional.silu(x)
def _sigmoid(x):
    return torch.sigmoid(x)
def _layernorm(x, axis=-1, eps=1e-5):
    m = x.mean(dim=axis, keepdim=True)
    v = x.var(dim=axis, keepdim=True, unbiased=False)
    return (x - m) / torch.sqrt(v + eps)
def _scatter_add(tgt, idx, src, axis=0):
    return tgt.clone().index_add_(axis, idx, src)
def _segment_sum(src, seg, n):
    out = torch.zeros((n,) + src.shape[1:], dtype=src.dtype)
    return out.index_add_(0, seg, src)
def _pad(x, pw):
    flat = tuple(v for pair in reversed(pw) for v in pair)
    return torch.nn.functional.pad(x, flat)

kernel_name = 'gated_mix__mha_block_cached__swiglu_ffn__decode'

def setup_inputs():

    _w = (lambda a: (lambda t: t.to(torch.bfloat16) if t.is_floating_point() else t)(torch.as_tensor(a)))
    def _A_setup():
        B, Sq, D = 8, 1, 576
        H, Sk, Dh = 32, 8192, 128
        return {
            "x": _w((lambda *s: torch.randn(*s, dtype=torch.bfloat16) * 0.05)(B, Sq, D)),
            "k_cache": _w((lambda *s: torch.randn(*s, dtype=torch.bfloat16) * 6.4)(B, H, Sk, Dh)),
            "v_cache": _w((lambda *s: torch.randn(*s, dtype=torch.bfloat16) * 0.4)(B, H, Sk, Dh)),
            "wq": _w((lambda *s: torch.randn(*s, dtype=torch.bfloat16) * 6.4)(D, H * Dh) * (D ** -0.5)),
            "wo": _w((lambda *s: torch.randn(*s, dtype=torch.bfloat16) * 0.4)(H * Dh, D) * ((H * Dh) ** -0.5)),
        }
    _A_in = _A_setup()

    def _B_setup():
        B, S, D, F = 8, 1, 576, 4608
        return {
            "x": _w((lambda *s: torch.randn(*s, dtype=torch.bfloat16) * 0.05)(B, S, D)),
            "w_gate": _w((lambda *s: torch.randn(*s, dtype=torch.bfloat16) * 0.05)(D, F)),
            "w_up": _w((lambda *s: torch.randn(*s, dtype=torch.bfloat16) * 0.05)(D, F)),
            "w_down": _w((lambda *s: torch.randn(*s, dtype=torch.bfloat16) * 0.05)(F, D)),
        }
    _B_in = _B_setup()

    return {
        "A_x": _A_in["x"],
        "A_k_cache": _A_in["k_cache"],
        "A_v_cache": _A_in["v_cache"],
        "A_wq": _A_in["wq"],
        "A_wo": _A_in["wo"],
        "B_x": _B_in["x"],
        "B_w_gate": _B_in["w_gate"],
        "B_w_up": _B_in["w_up"],
        "B_w_down": _B_in["w_down"],
        "gate_w": _w((lambda *s: torch.randn(*s, dtype=torch.bfloat16) * 0.05)(576) * 16.0),
    }

def reference(A_x, A_k_cache, A_v_cache, A_wq, A_wo, B_x, B_w_gate, B_w_up, B_w_down, gate_w):
    def _A_ref(x, k_cache, v_cache, wq, wo):
        B, Sq, D = x.shape
        H, Dh = 32, 128
        q = (lambda x, *d: x.permute(*d))((x @ wq).reshape(B, Sq, H, Dh), 0, 2, 1, 3)
        scores = torch.einsum("bhqd,bhkd->bhqk", q, k_cache) * (Dh ** -0.5)
        p = _softmax(scores, axis=-1)
        o = torch.einsum("bhqk,bhkd->bhqd", p, v_cache)
        return (lambda x, *d: x.permute(*d))(o, 0, 2, 1, 3).reshape(B, Sq, H * Dh) @ wo

    def _B_ref(x, w_gate, w_up, w_down):
        g = _silu(x @ w_gate)
        u = x @ w_up
        return (g * u) @ w_down

    x = A_x
    g = _sigmoid((x * gate_w).sum(-1, keepdims=True))
    a = _A_ref(x, A_k_cache, A_v_cache, A_wq, A_wo)
    b = _B_ref(x, B_w_gate, B_w_up, B_w_down)
    return g * a + (1 - g) * b
```

```asm
; @launch grid=(256,1,1) block=(512,1,1) lds=163840
.amdgcn_target "amdgcn-amd-amdhsa--gfx950"
.text
.globl gated_mix__mha_block_cached__swiglu_ffn__decode_kernel
.p2align 8
.type gated_mix__mha_block_cached__swiglu_ffn__decode_kernel,@function
gated_mix__mha_block_cached__swiglu_ffn__decode_kernel:
  s_cmp_ge_u32 s2, 256
  s_cbranch_scc1 L_done
  s_load_dwordx16 s[4:19], s[0:1], 0
  s_load_dwordx8 s[20:27], s[0:1], 64
  s_load_dwordx2 s[28:29], s[0:1], 96
  v_lshrrev_b32 v1, 6, v0
  v_and_b32 v0, 63, v0
  v_readfirstlane_b32 s3, v1
  s_lshr_b32 s30, s2, 5
  s_and_b32 s31, s2, 7
  s_lshl_b32 s31, s31, 2
  s_bfe_u32 s33, s2, 0x20003
  s_add_u32 s31, s31, s33
  s_cmp_eq_u32 s3, 0
  s_cbranch_scc1 L_loader
  s_barrier
  s_branch L_roles
L_loader:
  s_setprio 3
  v_mov_b32 v3, 122880
  v_lshl_add_u32 v6, v0, 2, v3
  v_mov_b32 v4, 0
  v_mov_b32 v5, 0
  ds_write_b32 v6, v4
  v_mov_b32 v6, 0
  v_bfe_u32 v1, v0, 2, 2
  v_lshlrev_b32 v1, 8, v1
  v_lshrrev_b32 v2, 4, v0
  v_lshl_add_u32 v1, v2, 6, v1
  v_and_b32 v2, 3, v0
  v_lshl_add_u32 v1, v2, 4, v1
  v_lshlrev_b32 v2, 4, v0
  s_lshl_b32 s44, s30, 5
  s_add_u32 s44, s44, s31
  s_lshl_b32 s44, s44, 21
  s_mul_i32 s40, s30, 786432
  s_and_b32 s40, s40, 0x1fffff
  s_mov_b32 s41, 0
  s_mov_b32 s42, 0
  s_add_u32 s43, s40, 4096
  v_lshrrev_b32 v9, 3, v0
  v_lshlrev_b32 v9, 13, v9
  v_and_b32 v10, 7, v0
  v_lshl_add_u32 v9, v10, 7, v9
  s_lshr_b32 s56, s2, 3
  s_mul_i32 s46, s56, 147456
  s_and_b32 s57, s2, 7
  s_lshl_b32 s47, s57, 10
  s_add_u32 s46, s46, s47
  s_waitcnt lgkmcnt(0)
  s_mov_b32 s48, s10
  s_and_b32 s49, s11, 0xffff
  s_mov_b32 s50, 4718592
  s_mov_b32 s51, 0x20000
  buffer_load_dword v16, v9, s[48:51], s46 offen
  s_add_u32 s46, s46, 65536
  buffer_load_dword v16, v9, s[48:51], s46 offen
  s_add_u32 s46, s46, 65536
  s_mov_b64 exec, 0xffff
  buffer_load_dword v16, v9, s[48:51], s46 offen
  s_mov_b64 exec, -1
  s_barrier
  s_add_u32 s32, s6, s44
  s_addc_u32 s33, s7, 0
  s_and_b32 s33, s33, 0xffff
  s_mov_b32 s34, 2097152
  s_mov_b32 s35, 0x20000
  s_add_u32 s36, s8, s44
  s_addc_u32 s37, s9, 0
  s_and_b32 s37, s37, 0xffff
  s_mov_b32 s38, 2097152
  s_mov_b32 s39, 0x20000
  s_mov_b32 s48, s16
  s_and_b32 s49, s17, 0xffff
  s_mov_b32 s50, 5308416
  s_mov_b32 s51, 0x20000
  s_mov_b32 s52, s18
  s_and_b32 s53, s19, 0xffff
  s_mov_b32 s54, 5308416
  s_mov_b32 s55, 0x20000
  s_mov_b32 s60, s20
  s_and_b32 s61, s21, 0xffff
  s_mov_b32 s62, 5308416
  s_mov_b32 s63, 0x20000
  s_mov_b32 s64, s12
  s_and_b32 s65, s13, 0xffff
  s_mov_b32 s66, 4718592
  s_mov_b32 s67, 0x20000
  v_lshlrev_b32 v9, 7, v0
  v_mov_b32 v17, 1
  s_lshl_b32 s47, s57, 5
  s_add_u32 s47, s47, s56
  s_mul_i32 s46, s47, 20736
  s_mul_i32 s47, s47, 18432
  v_add_u32 v12, 0, v0
  v_mul_u32_u24 v10, 7282, v12
  v_lshrrev_b32 v10, 16, v10
  v_mul_u32_u24 v11, 9, v10
  v_sub_u32 v12, v12, v11
  v_lshlrev_b32 v12, 7, v12
  v_mul_u32_u24 v10, 9216, v10
  v_add_u32 v20, v12, v10
  v_add_u32 v12, 64, v0
  v_mul_u32_u24 v10, 7282, v12
  v_lshrrev_b32 v10, 16, v10
  v_mul_u32_u24 v11, 9, v10
  v_sub_u32 v12, v12, v11
  v_lshlrev_b32 v12, 7, v12
  v_mul_u32_u24 v10, 9216, v10
  v_add_u32 v21, v12, v10
  v_add_u32 v12, 128, v0
  v_mul_u32_u24 v10, 7282, v12
  v_lshrrev_b32 v10, 16, v10
  v_mul_u32_u24 v11, 9, v10
  v_sub_u32 v12, v12, v11
  v_lshlrev_b32 v12, 7, v12
  v_mul_u32_u24 v10, 9216, v10
  v_add_u32 v22, v12, v10
  s_mul_i32 s58, s56, 165888
  s_mul_i32 s59, s57, 1152
  s_add_u32 s58, s58, s59
  s_waitcnt vmcnt(2)
  buffer_load_dword v16, v20, s[48:51], s58 offen
  s_waitcnt vmcnt(2)
  buffer_load_dword v16, v21, s[48:51], s58 offen
  s_mov_b32 exec_hi, 3
  s_waitcnt vmcnt(2)
  ds_write_b32 v3, v17 offset:44
  buffer_load_dword v16, v22, s[48:51], s58 offen
  s_mov_b64 exec, -1
  s_waitcnt vmcnt(2)
  buffer_load_dword v16, v20, s[52:55], s58 offen
  s_waitcnt vmcnt(2)
  buffer_load_dword v16, v21, s[52:55], s58 offen
  s_mov_b32 exec_hi, 3
  s_waitcnt vmcnt(2)
  buffer_load_dword v16, v22, s[52:55], s58 offen
  s_mov_b64 exec, -1
  s_waitcnt vmcnt(2)
  buffer_load_dword v16, v9, s[60:63], s46 offen
  s_add_u32 s46, s46, 8192
  s_waitcnt vmcnt(2)
  buffer_load_dword v16, v9, s[60:63], s46 offen
  s_add_u32 s46, s46, 8192
  s_mov_b32 exec_hi, 3
  s_waitcnt vmcnt(2)
  buffer_load_dword v16, v9, s[60:63], s46 offen
  s_mov_b64 exec, -1
  s_waitcnt vmcnt(2)
  buffer_load_dword v16, v9, s[64:67], s47 offen
  s_add_u32 s47, s47, 8192
  s_waitcnt vmcnt(2)
  buffer_load_dword v16, v9, s[64:67], s47 offen
  s_add_u32 s47, s47, 8192
  s_mov_b64 exec, 0xffff
  s_waitcnt vmcnt(2)
  buffer_load_dword v16, v9, s[64:67], s47 offen
  s_mov_b64 exec, -1
L_l0:
  s_waitcnt lgkmcnt(0)
  v_min_u32 v4, v4, v5
  s_nop 0
  v_readfirstlane_b32 s45, v4
  s_add_u32 s45, s45, 15
  s_cmp_gt_u32 s45, s41
  s_cbranch_scc0 L_l0_full
L_l0_ok:
  s_waitcnt vmcnt(23)
  s_mov_b32 m0, s42
  s_nop 0
  buffer_load_dwordx4 v1, s[32:35], s40 offen offset:0 nt lds
  s_waitcnt vmcnt(23)
  buffer_load_dwordx4 v1, s[32:35], s40 offen offset:1024 nt lds
  s_waitcnt vmcnt(23)
  buffer_load_dwordx4 v1, s[32:35], s40 offen offset:2048 nt lds
  s_waitcnt vmcnt(23)
  buffer_load_dwordx4 v1, s[32:35], s40 offen offset:3072 nt lds
  s_waitcnt vmcnt(23)
  s_add_u32 m0, s42, 4096
  s_nop 0
  buffer_load_dwordx4 v1, s[32:35], s43 offen offset:0 nt lds
  s_waitcnt vmcnt(23)
  buffer_load_dwordx4 v1, s[32:35], s43 offen offset:1024 nt lds
  s_waitcnt vmcnt(23)
  buffer_load_dwordx4 v1, s[32:35], s43 offen offset:2048 nt lds
  s_waitcnt vmcnt(23)
  buffer_load_dwordx4 v1, s[32:35], s43 offen offset:3072 nt lds
  s_sub_u32 s45, s41, 2
  s_max_i32 s45, s45, 0
  v_mov_b32 v8, s45
  ds_write_b32 v3, v8
  ds_read_b128 v[4:7], v3 offset:16
  s_add_u32 s40, s40, 8192
  s_and_b32 s40, s40, 0x1fffff
  s_add_u32 s43, s40, 4096
  s_add_u32 s42, s42, 8192
  s_cmp_eq_u32 s42, 122880
  s_cselect_b32 s42, 0, s42
  s_add_u32 s41, s41, 1
  s_cmp_lt_u32 s41, 16
  s_cbranch_scc1 L_l0
L_l0_end:
L_l16:
  s_waitcnt lgkmcnt(0)
  v_min_u32 v4, v4, v5
  s_nop 0
  v_readfirstlane_b32 s45, v4
  s_add_u32 s45, s45, 15
  s_cmp_gt_u32 s45, s41
  s_cbranch_scc0 L_l16_full
L_l16_ok:
  s_waitcnt vmcnt(19)
  s_mov_b32 m0, s42
  s_nop 0
  buffer_load_dwordx4 v1, s[32:35], s40 offen offset:0 nt lds
  s_waitcnt vmcnt(19)
  buffer_load_dwordx4 v1, s[32:35], s40 offen offset:1024 nt lds
  s_waitcnt vmcnt(19)
  buffer_load_dwordx4 v1, s[32:35], s40 offen offset:2048 nt lds
  s_waitcnt vmcnt(19)
  buffer_load_dwordx4 v1, s[32:35], s40 offen offset:3072 nt lds
  s_sub_u32 s45, s41, 2
  s_max_i32 s45, s45, 0
  v_mov_b32 v8, s45
  ds_write_b32 v3, v8
  ds_read_b128 v[4:7], v3 offset:16
  s_waitcnt vmcnt(19)
  s_add_u32 m0, s42, 4096
  s_nop 0
  buffer_load_dwordx4 v1, s[32:35], s43 offen offset:0 nt lds
  s_waitcnt vmcnt(19)
  buffer_load_dwordx4 v1, s[32:35], s43 offen offset:1024 nt lds
  s_waitcnt vmcnt(19)
  buffer_load_dwordx4 v1, s[32:35], s43 offen offset:2048 nt lds
  s_waitcnt vmcnt(19)
  buffer_load_dwordx4 v1, s[32:35], s43 offen offset:3072 nt lds
  s_add_u32 s40, s40, 8192
  s_and_b32 s40, s40, 0x1fffff
  s_add_u32 s43, s40, 4096
  s_add_u32 s42, s42, 8192
  s_cmp_eq_u32 s42, 122880
  s_cselect_b32 s42, 0, s42
  s_add_u32 s41, s41, 1
  s_cmp_lt_u32 s41, 170
  s_cbranch_scc1 L_l16
L_l16_end:
L_l170:
  s_waitcnt lgkmcnt(0)
  v_min_u32 v4, v4, v5
  v_readfirstlane_b32 s46, v6
  v_readfirstlane_b32 s45, v4
  s_cmp_lg_u32 s46, 0
  s_cbranch_scc1 L_ld170
L_l170_in:
  s_add_u32 s45, s45, 15
  s_cmp_gt_u32 s45, s41
  s_cbranch_scc0 L_l170_full
L_l170_ok:
  s_waitcnt vmcnt(19)
  s_mov_b32 m0, s42
  s_nop 0
  buffer_load_dwordx4 v1, s[32:35], s40 offen offset:0 nt lds
  s_waitcnt vmcnt(19)
  buffer_load_dwordx4 v1, s[32:35], s40 offen offset:1024 nt lds
  s_waitcnt vmcnt(19)
  buffer_load_dwordx4 v1, s[32:35], s40 offen offset:2048 nt lds
  s_waitcnt vmcnt(19)
  buffer_load_dwordx4 v1, s[32:35], s40 offen offset:3072 nt lds
  s_sub_u32 s45, s41, 2
  s_max_i32 s45, s45, 0
  v_mov_b32 v8, s45
  ds_write_b32 v3, v8
  ds_read_b128 v[4:7], v3 offset:16
  s_waitcnt vmcnt(19)
  s_add_u32 m0, s42, 4096
  s_nop 0
  buffer_load_dwordx4 v1, s[32:35], s43 offen offset:0 nt lds
  s_waitcnt vmcnt(19)
  buffer_load_dwordx4 v1, s[32:35], s43 offen offset:1024 nt lds
  s_waitcnt vmcnt(19)
  buffer_load_dwordx4 v1, s[32:35], s43 offen offset:2048 nt lds
  s_waitcnt vmcnt(19)
  buffer_load_dwordx4 v1, s[32:35], s43 offen offset:3072 nt lds
  s_add_u32 s40, s40, 8192
  s_and_b32 s40, s40, 0x1fffff
  s_add_u32 s43, s40, 4096
  s_add_u32 s42, s42, 8192
  s_cmp_eq_u32 s42, 122880
  s_cselect_b32 s42, 0, s42
  s_add_u32 s41, s41, 1
  s_cmp_lt_u32 s41, 256
  s_cbranch_scc1 L_l170
L_l170_end:
L_l256:
  s_waitcnt lgkmcnt(0)
  v_min_u32 v4, v4, v5
  v_readfirstlane_b32 s46, v6
  v_readfirstlane_b32 s45, v4
  s_cmp_lg_u32 s46, 0
  s_cbranch_scc1 L_ld256
L_l256_in:
  s_add_u32 s45, s45, 15
  s_cmp_gt_u32 s45, s41
  s_cbranch_scc0 L_l256_full
L_l256_ok:
  s_waitcnt vmcnt(19)
  s_mov_b32 m0, s42
  s_nop 0
  buffer_load_dwordx4 v2, s[36:39], s40 offen offset:0 nt lds
  s_waitcnt vmcnt(19)
  buffer_load_dwordx4 v2, s[36:39], s40 offen offset:1024 nt lds
  s_waitcnt vmcnt(19)
  buffer_load_dwordx4 v2, s[36:39], s40 offen offset:2048 nt lds
  s_waitcnt vmcnt(19)
  buffer_load_dwordx4 v2, s[36:39], s40 offen offset:3072 nt lds
  s_sub_u32 s45, s41, 2
  s_max_i32 s45, s45, 0
  v_mov_b32 v8, s45
  ds_write_b32 v3, v8
  ds_read_b128 v[4:7], v3 offset:16
  s_waitcnt vmcnt(19)
  s_add_u32 m0, s42, 4096
  s_nop 0
  buffer_load_dwordx4 v2, s[36:39], s43 offen offset:0 nt lds
  s_waitcnt vmcnt(19)
  buffer_load_dwordx4 v2, s[36:39], s43 offen offset:1024 nt lds
  s_waitcnt vmcnt(19)
  buffer_load_dwordx4 v2, s[36:39], s43 offen offset:2048 nt lds
  s_waitcnt vmcnt(19)
  buffer_load_dwordx4 v2, s[36:39], s43 offen offset:3072 nt lds
  s_add_u32 s40, s40, 8192
  s_and_b32 s40, s40, 0x1fffff
  s_add_u32 s43, s40, 4096
  s_add_u32 s42, s42, 8192
  s_cmp_eq_u32 s42, 122880
  s_cselect_b32 s42, 0, s42
  s_add_u32 s41, s41, 1
  s_cmp_lt_u32 s41, 512
  s_cbranch_scc1 L_l256
L_l256_end:
  s_waitcnt vmcnt(40)
  v_mov_b32 v8, 507
  ds_write_b32 v3, v8
  s_waitcnt vmcnt(32)
  v_mov_b32 v8, 508
  ds_write_b32 v3, v8
  s_waitcnt vmcnt(24)
  v_mov_b32 v8, 509
  ds_write_b32 v3, v8
  s_waitcnt vmcnt(16)
  v_mov_b32 v8, 510
  ds_write_b32 v3, v8
  s_waitcnt vmcnt(8)
  v_mov_b32 v8, 511
  ds_write_b32 v3, v8
  s_waitcnt vmcnt(0)
  v_mov_b32 v8, 512
  ds_write_b32 v3, v8
  s_waitcnt lgkmcnt(0)
  s_endpgm
L_ld170:
  s_cmp_eq_u32 s46, 2
  s_cbranch_scc1 L_l170c2_in
  s_cmp_eq_u32 s46, 3
  s_cbranch_scc1 L_l170c3_in
  s_branch L_l170_in
L_l170c2:
  s_waitcnt lgkmcnt(0)
  v_min_u32 v4, v4, v5
  v_readfirstlane_b32 s46, v6
  v_readfirstlane_b32 s45, v4
  s_cmp_lg_u32 s46, 2
  s_cbranch_scc1 L_ld170
L_l170c2_in:
  s_add_u32 s45, s45, 15
  s_cmp_gt_u32 s45, s41
  s_cbranch_scc0 L_l170c2_full
L_l170c2_ok:
  s_waitcnt vmcnt(18)
  s_mov_b32 m0, s42
  s_nop 0
  buffer_load_dwordx4 v1, s[32:35], s40 offen offset:0 nt lds
  s_waitcnt vmcnt(18)
  buffer_load_dwordx4 v1, s[32:35], s40 offen offset:1024 nt lds
  s_waitcnt vmcnt(18)
  buffer_load_dwordx4 v1, s[32:35], s40 offen offset:2048 nt lds
  s_sub_u32 s45, s41, 2
  s_max_i32 s45, s45, 0
  v_mov_b32 v8, s45
  ds_write_b32 v3, v8
  ds_read_b128 v[4:7], v3 offset:16
  s_waitcnt vmcnt(18)
  buffer_load_dwordx4 v1, s[32:35], s40 offen offset:3072 nt lds
  s_waitcnt vmcnt(18)
  s_add_u32 m0, s42, 4096
  s_nop 0
  buffer_load_dwordx4 v1, s[32:35], s43 offen offset:0 nt lds
  s_waitcnt vmcnt(18)
  buffer_load_dwordx4 v1, s[32:35], s43 offen offset:1024 nt lds
  s_waitcnt vmcnt(18)
  buffer_load_dwordx4 v1, s[32:35], s43 offen offset:2048 nt lds
  s_waitcnt vmcnt(18)
  buffer_load_dwordx4 v1, s[32:35], s43 offen offset:3072 nt lds
  s_add_u32 s40, s40, 8192
  s_and_b32 s40, s40, 0x1fffff
  s_add_u32 s43, s40, 4096
  s_add_u32 s42, s42, 8192
  s_cmp_eq_u32 s42, 122880
  s_cselect_b32 s42, 0, s42
  s_add_u32 s41, s41, 1
  s_cmp_lt_u32 s41, 256
  s_cbranch_scc1 L_l170c2
  s_branch L_l170_end
L_l170c3:
  s_waitcnt lgkmcnt(0)
  v_min_u32 v4, v4, v5
  v_readfirstlane_b32 s46, v6
  v_readfirstlane_b32 s45, v4
  s_cmp_lg_u32 s46, 3
  s_cbranch_scc1 L_ld170
L_l170c3_in:
  s_add_u32 s45, s45, 15
  s_cmp_gt_u32 s45, s41
  s_cbranch_scc0 L_l170c3_full
L_l170c3_ok:
  s_waitcnt vmcnt(20)
  s_mov_b32 m0, s42
  s_nop 0
  buffer_load_dwordx4 v1, s[32:35], s40 offen offset:0 nt lds
  s_waitcnt vmcnt(20)
  buffer_load_dwordx4 v1, s[32:35], s40 offen offset:1024 nt lds
  s_waitcnt vmcnt(20)
  buffer_load_dwordx4 v1, s[32:35], s40 offen offset:2048 nt lds
  s_waitcnt vmcnt(20)
  buffer_load_dwordx4 v1, s[32:35], s40 offen offset:3072 nt lds
  s_waitcnt vmcnt(20)
  s_add_u32 m0, s42, 4096
  s_nop 0
  buffer_load_dwordx4 v1, s[32:35], s43 offen offset:0 nt lds
  s_sub_u32 s45, s41, 2
  s_max_i32 s45, s45, 0
  v_mov_b32 v8, s45
  ds_write_b32 v3, v8
  ds_read_b128 v[4:7], v3 offset:16
  s_waitcnt vmcnt(20)
  buffer_load_dwordx4 v1, s[32:35], s43 offen offset:1024 nt lds
  s_waitcnt vmcnt(20)
  buffer_load_dwordx4 v1, s[32:35], s43 offen offset:2048 nt lds
  s_waitcnt vmcnt(20)
  buffer_load_dwordx4 v1, s[32:35], s43 offen offset:3072 nt lds
  s_add_u32 s40, s40, 8192
  s_and_b32 s40, s40, 0x1fffff
  s_add_u32 s43, s40, 4096
  s_add_u32 s42, s42, 8192
  s_cmp_eq_u32 s42, 122880
  s_cselect_b32 s42, 0, s42
  s_add_u32 s41, s41, 1
  s_cmp_lt_u32 s41, 256
  s_cbranch_scc1 L_l170c3
  s_branch L_l170_end
L_ld256:
  s_cmp_eq_u32 s46, 2
  s_cbranch_scc1 L_l256c2_in
  s_cmp_eq_u32 s46, 3
  s_cbranch_scc1 L_l256c3_in
  s_cmp_eq_u32 s46, 1
  s_cbranch_scc1 L_l256c1_in
  s_cmp_eq_u32 s46, 4
  s_cbranch_scc1 L_l256c4_in
  s_branch L_l256_in
L_l256c2:
  s_waitcnt lgkmcnt(0)
  v_min_u32 v4, v4, v5
  v_readfirstlane_b32 s46, v6
  v_readfirstlane_b32 s45, v4
  s_cmp_lg_u32 s46, 2
  s_cbranch_scc1 L_ld256
L_l256c2_in:
  s_add_u32 s45, s45, 15
  s_cmp_gt_u32 s45, s41
  s_cbranch_scc0 L_l256c2_full
L_l256c2_ok:
  s_waitcnt vmcnt(18)
  s_mov_b32 m0, s42
  s_nop 0
  buffer_load_dwordx4 v2, s[36:39], s40 offen offset:0 nt lds
  s_waitcnt vmcnt(18)
  buffer_load_dwordx4 v2, s[36:39], s40 offen offset:1024 nt lds
  s_waitcnt vmcnt(18)
  buffer_load_dwordx4 v2, s[36:39], s40 offen offset:2048 nt lds
  s_sub_u32 s45, s41, 2
  s_max_i32 s45, s45, 0
  v_mov_b32 v8, s45
  ds_write_b32 v3, v8
  ds_read_b128 v[4:7], v3 offset:16
  s_waitcnt vmcnt(18)
  buffer_load_dwordx4 v2, s[36:39], s40 offen offset:3072 nt lds
  s_waitcnt vmcnt(18)
  s_add_u32 m0, s42, 4096
  s_nop 0
  buffer_load_dwordx4 v2, s[36:39], s43 offen offset:0 nt lds
  s_waitcnt vmcnt(18)
  buffer_load_dwordx4 v2, s[36:39], s43 offen offset:1024 nt lds
  s_waitcnt vmcnt(18)
  buffer_load_dwordx4 v2, s[36:39], s43 offen offset:2048 nt lds
  s_waitcnt vmcnt(18)
  buffer_load_dwordx4 v2, s[36:39], s43 offen offset:3072 nt lds
  s_add_u32 s40, s40, 8192
  s_and_b32 s40, s40, 0x1fffff
  s_add_u32 s43, s40, 4096
  s_add_u32 s42, s42, 8192
  s_cmp_eq_u32 s42, 122880
  s_cselect_b32 s42, 0, s42
  s_add_u32 s41, s41, 1
  s_cmp_lt_u32 s41, 512
  s_cbranch_scc1 L_l256c2
  s_branch L_l256_end
L_l256c3:
  s_waitcnt lgkmcnt(0)
  v_min_u32 v4, v4, v5
  v_readfirstlane_b32 s46, v6
  v_readfirstlane_b32 s45, v4
  s_cmp_lg_u32 s46, 3
  s_cbranch_scc1 L_ld256
L_l256c3_in:
  s_add_u32 s45, s45, 15
  s_cmp_gt_u32 s45, s41
  s_cbranch_scc0 L_l256c3_full
L_l256c3_ok:
  s_waitcnt vmcnt(20)
  s_mov_b32 m0, s42
  s_nop 0
  buffer_load_dwordx4 v2, s[36:39], s40 offen offset:0 nt lds
  s_waitcnt vmcnt(20)
  buffer_load_dwordx4 v2, s[36:39], s40 offen offset:1024 nt lds
  s_waitcnt vmcnt(20)
  buffer_load_dwordx4 v2, s[36:39], s40 offen offset:2048 nt lds
  s_waitcnt vmcnt(20)
  buffer_load_dwordx4 v2, s[36:39], s40 offen offset:3072 nt lds
  s_waitcnt vmcnt(20)
  s_add_u32 m0, s42, 4096
  s_nop 0
  buffer_load_dwordx4 v2, s[36:39], s43 offen offset:0 nt lds
  s_sub_u32 s45, s41, 2
  s_max_i32 s45, s45, 0
  v_mov_b32 v8, s45
  ds_write_b32 v3, v8
  ds_read_b128 v[4:7], v3 offset:16
  s_waitcnt vmcnt(20)
  buffer_load_dwordx4 v2, s[36:39], s43 offen offset:1024 nt lds
  s_waitcnt vmcnt(20)
  buffer_load_dwordx4 v2, s[36:39], s43 offen offset:2048 nt lds
  s_waitcnt vmcnt(20)
  buffer_load_dwordx4 v2, s[36:39], s43 offen offset:3072 nt lds
  s_add_u32 s40, s40, 8192
  s_and_b32 s40, s40, 0x1fffff
  s_add_u32 s43, s40, 4096
  s_add_u32 s42, s42, 8192
  s_cmp_eq_u32 s42, 122880
  s_cselect_b32 s42, 0, s42
  s_add_u32 s41, s41, 1
  s_cmp_lt_u32 s41, 512
  s_cbranch_scc1 L_l256c3
  s_branch L_l256_end
L_l256c1:
  s_waitcnt lgkmcnt(0)
  v_min_u32 v4, v4, v5
  v_readfirstlane_b32 s46, v6
  v_readfirstlane_b32 s45, v4
  s_cmp_lg_u32 s46, 1
  s_cbranch_scc1 L_ld256
L_l256c1_in:
  s_add_u32 s45, s45, 15
  s_cmp_gt_u32 s45, s41
  s_cbranch_scc0 L_l256c1_full
L_l256c1_ok:
  s_waitcnt vmcnt(39)
  s_mov_b32 m0, s42
  s_nop 0
  buffer_load_dwordx4 v2, s[36:39], s40 offen offset:0 nt lds
  s_waitcnt vmcnt(39)
  buffer_load_dwordx4 v2, s[36:39], s40 offen offset:1024 nt lds
  s_waitcnt vmcnt(39)
  buffer_load_dwordx4 v2, s[36:39], s40 offen offset:2048 nt lds
  s_waitcnt vmcnt(39)
  buffer_load_dwordx4 v2, s[36:39], s40 offen offset:3072 nt lds
  s_waitcnt vmcnt(39)
  s_add_u32 m0, s42, 4096
  s_nop 0
  buffer_load_dwordx4 v2, s[36:39], s43 offen offset:0 nt lds
  s_waitcnt vmcnt(39)
  buffer_load_dwordx4 v2, s[36:39], s43 offen offset:1024 nt lds
  s_waitcnt vmcnt(39)
  buffer_load_dwordx4 v2, s[36:39], s43 offen offset:2048 nt lds
  s_waitcnt vmcnt(39)
  buffer_load_dwordx4 v2, s[36:39], s43 offen offset:3072 nt lds
  s_sub_u32 s45, s41, 4
  s_max_i32 s45, s45, 0
  v_mov_b32 v8, s45
  ds_write_b32 v3, v8
  ds_read_b128 v[4:7], v3 offset:16
  s_add_u32 s40, s40, 8192
  s_and_b32 s40, s40, 0x1fffff
  s_add_u32 s43, s40, 4096
  s_add_u32 s42, s42, 8192
  s_cmp_eq_u32 s42, 122880
  s_cselect_b32 s42, 0, s42
  s_add_u32 s41, s41, 1
  s_cmp_lt_u32 s41, 512
  s_cbranch_scc1 L_l256c1
  s_branch L_l256_end
L_l256c4:
  s_waitcnt lgkmcnt(0)
  v_min_u32 v4, v4, v5
  v_readfirstlane_b32 s46, v6
  v_readfirstlane_b32 s45, v4
  s_cmp_lg_u32 s46, 4
  s_cbranch_scc1 L_ld256
L_l256c4_in:
  s_add_u32 s45, s45, 15
  s_cmp_gt_u32 s45, s41
  s_cbranch_scc0 L_l256c4_full
L_l256c4_ok:
  s_waitcnt vmcnt(16)
  s_mov_b32 m0, s42
  s_nop 0
  buffer_load_dwordx4 v2, s[36:39], s40 offen offset:0 nt lds
  s_sub_u32 s45, s41, 2
  s_max_i32 s45, s45, 0
  v_mov_b32 v8, s45
  ds_write_b32 v3, v8
  ds_read_b128 v[4:7], v3 offset:16
  s_waitcnt vmcnt(16)
  buffer_load_dwordx4 v2, s[36:39], s40 offen offset:1024 nt lds
  s_waitcnt vmcnt(16)
  buffer_load_dwordx4 v2, s[36:39], s40 offen offset:2048 nt lds
  s_waitcnt vmcnt(16)
  buffer_load_dwordx4 v2, s[36:39], s40 offen offset:3072 nt lds
  s_waitcnt vmcnt(16)
  s_add_u32 m0, s42, 4096
  s_nop 0
  buffer_load_dwordx4 v2, s[36:39], s43 offen offset:0 nt lds
  s_waitcnt vmcnt(16)
  buffer_load_dwordx4 v2, s[36:39], s43 offen offset:1024 nt lds
  s_waitcnt vmcnt(16)
  buffer_load_dwordx4 v2, s[36:39], s43 offen offset:2048 nt lds
  s_waitcnt vmcnt(16)
  buffer_load_dwordx4 v2, s[36:39], s43 offen offset:3072 nt lds
  s_add_u32 s40, s40, 8192
  s_and_b32 s40, s40, 0x1fffff
  s_add_u32 s43, s40, 4096
  s_add_u32 s42, s42, 8192
  s_cmp_eq_u32 s42, 122880
  s_cselect_b32 s42, 0, s42
  s_add_u32 s41, s41, 1
  s_cmp_lt_u32 s41, 512
  s_cbranch_scc1 L_l256c4
  s_branch L_l256_end
L_l0_full:
  s_sleep 1
  ds_read_b64 v[4:5], v3 offset:16
  s_waitcnt lgkmcnt(0)
  v_min_u32 v4, v4, v5
  s_nop 0
  v_readfirstlane_b32 s45, v4
  s_add_u32 s45, s45, 15
  s_cmp_gt_u32 s45, s41
  s_cbranch_scc0 L_l0_full
  s_branch L_l0_ok
L_l16_full:
  s_sleep 1
  ds_read_b64 v[4:5], v3 offset:16
  s_waitcnt lgkmcnt(0)
  v_min_u32 v4, v4, v5
  s_nop 0
  v_readfirstlane_b32 s45, v4
  s_add_u32 s45, s45, 15
  s_cmp_gt_u32 s45, s41
  s_cbranch_scc0 L_l16_full
  s_branch L_l16_ok
L_l170_full:
  s_sleep 1
  ds_read_b64 v[4:5], v3 offset:16
  s_waitcnt lgkmcnt(0)
  v_min_u32 v4, v4, v5
  s_nop 0
  v_readfirstlane_b32 s45, v4
  s_add_u32 s45, s45, 15
  s_cmp_gt_u32 s45, s41
  s_cbranch_scc0 L_l170_full
  s_branch L_l170_ok
L_l256_full:
  s_sleep 1
  ds_read_b64 v[4:5], v3 offset:16
  s_waitcnt lgkmcnt(0)
  v_min_u32 v4, v4, v5
  s_nop 0
  v_readfirstlane_b32 s45, v4
  s_add_u32 s45, s45, 15
  s_cmp_gt_u32 s45, s41
  s_cbranch_scc0 L_l256_full
  s_branch L_l256_ok
L_l170c2_full:
  s_sleep 1
  ds_read_b64 v[4:5], v3 offset:16
  s_waitcnt lgkmcnt(0)
  v_min_u32 v4, v4, v5
  s_nop 0
  v_readfirstlane_b32 s45, v4
  s_add_u32 s45, s45, 15
  s_cmp_gt_u32 s45, s41
  s_cbranch_scc0 L_l170c2_full
  s_branch L_l170c2_ok
L_l170c3_full:
  s_sleep 1
  ds_read_b64 v[4:5], v3 offset:16
  s_waitcnt lgkmcnt(0)
  v_min_u32 v4, v4, v5
  s_nop 0
  v_readfirstlane_b32 s45, v4
  s_add_u32 s45, s45, 15
  s_cmp_gt_u32 s45, s41
  s_cbranch_scc0 L_l170c3_full
  s_branch L_l170c3_ok
L_l256c2_full:
  s_sleep 1
  ds_read_b64 v[4:5], v3 offset:16
  s_waitcnt lgkmcnt(0)
  v_min_u32 v4, v4, v5
  s_nop 0
  v_readfirstlane_b32 s45, v4
  s_add_u32 s45, s45, 15
  s_cmp_gt_u32 s45, s41
  s_cbranch_scc0 L_l256c2_full
  s_branch L_l256c2_ok
L_l256c3_full:
  s_sleep 1
  ds_read_b64 v[4:5], v3 offset:16
  s_waitcnt lgkmcnt(0)
  v_min_u32 v4, v4, v5
  s_nop 0
  v_readfirstlane_b32 s45, v4
  s_add_u32 s45, s45, 15
  s_cmp_gt_u32 s45, s41
  s_cbranch_scc0 L_l256c3_full
  s_branch L_l256c3_ok
L_l256c1_full:
  s_sleep 1
  ds_read_b64 v[4:5], v3 offset:16
  s_waitcnt lgkmcnt(0)
  v_min_u32 v4, v4, v5
  s_nop 0
  v_readfirstlane_b32 s45, v4
  s_add_u32 s45, s45, 15
  s_cmp_gt_u32 s45, s41
  s_cbranch_scc0 L_l256c1_full
  s_branch L_l256c1_ok
L_l256c4_full:
  s_sleep 1
  ds_read_b64 v[4:5], v3 offset:16
  s_waitcnt lgkmcnt(0)
  v_min_u32 v4, v4, v5
  s_nop 0
  v_readfirstlane_b32 s45, v4
  s_add_u32 s45, s45, 15
  s_cmp_gt_u32 s45, s41
  s_cbranch_scc0 L_l256c4_full
  s_branch L_l256c4_ok
L_roles:
  s_cmp_lt_u32 s3, 3
  s_cbranch_scc1 L_cons
  s_cmp_eq_u32 s3, 7
  s_cbranch_scc1 L_init
  s_sub_u32 s44, s3, 3
  v_lshrrev_b32 v1, 4, v0
  v_and_b32 v2, 15, v0
  v_lshlrev_b32 v3, 13, v1
  v_lshl_add_u32 v3, v2, 4, v3
  s_mul_i32 s45, s44, 144
  v_lshl_add_u32 v11, v2, 2, v1
  v_add_u32 v11, s45, v11
  v_lshlrev_b32 v11, 1, v11
  s_lshl_b32 s46, s45, 13
  s_lshl_b32 s47, s31, 8
  s_add_u32 s46, s46, s47
  s_mul_i32 s47, s30, 1152
  s_waitcnt lgkmcnt(0)
  s_mov_b32 s32, s10
  s_and_b32 s33, s11, 0xffff
  s_mov_b32 s34, 4718592
  s_mov_b32 s35, 0x20000
  s_add_u32 s36, s4, s47
  s_addc_u32 s37, s5, 0
  s_and_b32 s37, s37, 0xffff
  s_mov_b32 s38, 1152
  s_mov_b32 s39, 0x20000
  buffer_load_ushort v8, v11, s[36:39], 0 offen offset:0
  buffer_load_ushort v9, v11, s[36:39], 0 offen offset:128
  buffer_load_ushort v10, v11, s[36:39], 0 offen offset:256
  v_mov_b32 v14, 122880
L_aum:
  ds_read_b32 v13, v14 offset:44
  s_waitcnt lgkmcnt(0)
  v_readfirstlane_b32 s45, v13
  s_cmp_ge_u32 s45, 1
  s_cbranch_scc1 L_aum_ok
  s_sleep 1
  s_branch L_aum
L_aum_ok:
  buffer_load_dwordx4 v[64:67], v3, s[32:35], s46 offen nt
  s_add_u32 s46, s46, 32768
  buffer_load_dwordx4 v[68:71], v3, s[32:35], s46 offen nt
  s_add_u32 s46, s46, 32768
  buffer_load_dwordx4 v[72:75], v3, s[32:35], s46 offen nt
  s_add_u32 s46, s46, 32768
  buffer_load_dwordx4 v[76:79], v3, s[32:35], s46 offen nt
  s_add_u32 s46, s46, 32768
  buffer_load_dwordx4 v[80:83], v3, s[32:35], s46 offen nt
  s_add_u32 s46, s46, 32768
  v_and_b32 v12, 1, v0
  v_lshlrev_b32 v12, 4, v12
  v_mov_b32 v13, 0xffff
  v_lshlrev_b32 v12, v12, v13
  v_bfe_u32 v13, v0, 1, 2
  v_cmp_eq_u32 vcc, 0, v13
  s_nop 1
  v_cndmask_b32 v4, 0, v12, vcc
  v_cmp_eq_u32 vcc, 1, v13
  s_nop 1
  v_cndmask_b32 v5, 0, v12, vcc
  v_cmp_eq_u32 vcc, 2, v13
  s_nop 1
  v_cndmask_b32 v6, 0, v12, vcc
  v_cmp_eq_u32 vcc, 3, v13
  s_nop 1
  v_cndmask_b32 v7, 0, v12, vcc
  s_waitcnt vmcnt(5)
  v_lshl_or_b32 v8, v8, 16, v8
  v_lshl_or_b32 v9, v9, 16, v9
  v_lshl_or_b32 v10, v10, 16, v10
  s_nop 1
  v_and_b32_dpp v16, v8, v4 row_newbcast:0 row_mask:0xf bank_mask:0xf
  v_and_b32_dpp v17, v8, v5 row_newbcast:0 row_mask:0xf bank_mask:0xf
  v_and_b32_dpp v18, v8, v6 row_newbcast:0 row_mask:0xf bank_mask:0xf
  v_and_b32_dpp v19, v8, v7 row_newbcast:0 row_mask:0xf bank_mask:0xf
  v_and_b32_dpp v20, v8, v4 row_newbcast:1 row_mask:0xf bank_mask:0xf
  v_and_b32_dpp v21, v8, v5 row_newbcast:1 row_mask:0xf bank_mask:0xf
  v_and_b32_dpp v22, v8, v6 row_newbcast:1 row_mask:0xf bank_mask:0xf
  v_and_b32_dpp v23, v8, v7 row_newbcast:1 row_mask:0xf bank_mask:0xf
  s_waitcnt vmcnt(4)
  buffer_load_dwordx4 v[84:87], v3, s[32:35], s46 offen nt
  s_add_u32 s46, s46, 32768
  v_mfma_f32_16x16x32_bf16 v[24:27], v[16:19], v[64:67], 0
  v_and_b32_dpp v16, v8, v4 row_newbcast:2 row_mask:0xf bank_mask:0xf
  v_and_b32_dpp v17, v8, v5 row_newbcast:2 row_mask:0xf bank_mask:0xf
  v_and_b32_dpp v18, v8, v6 row_newbcast:2 row_mask:0xf bank_mask:0xf
  v_and_b32_dpp v19, v8, v7 row_newbcast:2 row_mask:0xf bank_mask:0xf
  s_waitcnt vmcnt(4)
  buffer_load_dwordx4 v[88:91], v3, s[32:35], s46 offen nt
  s_add_u32 s46, s46, 32768
  v_mfma_f32_16x16x32_bf16 v[24:27], v[20:23], v[68:71], v[24:27]
  v_and_b32_dpp v20, v8, v4 row_newbcast:3 row_mask:0xf bank_mask:0xf
  v_and_b32_dpp v21, v8, v5 row_newbcast:3 row_mask:0xf bank_mask:0xf
  v_and_b32_dpp v22, v8, v6 row_newbcast:3 row_mask:0xf bank_mask:0xf
  v_and_b32_dpp v23, v8, v7 row_newbcast:3 row_mask:0xf bank_mask:0xf
  s_waitcnt vmcnt(4)
  buffer_load_dwordx4 v[92:95], v3, s[32:35], s46 offen nt
  s_add_u32 s46, s46, 32768
  v_mfma_f32_16x16x32_bf16 v[24:27], v[16:19], v[72:75], v[24:27]
  v_and_b32_dpp v16, v8, v4 row_newbcast:4 row_mask:0xf bank_mask:0xf
  v_and_b32_dpp v17, v8, v5 row_newbcast:4 row_mask:0xf bank_mask:0xf
  v_and_b32_dpp v18, v8, v6 row_newbcast:4 row_mask:0xf bank_mask:0xf
  v_and_b32_dpp v19, v8, v7 row_newbcast:4 row_mask:0xf bank_mask:0xf
  s_waitcnt vmcnt(4)
  buffer_load_dwordx4 v[96:99], v3, s[32:35], s46 offen nt
  s_add_u32 s46, s46, 32768
  v_mfma_f32_16x16x32_bf16 v[24:27], v[20:23], v[76:79], v[24:27]
  v_and_b32_dpp v20, v8, v4 row_newbcast:5 row_mask:0xf bank_mask:0xf
  v_and_b32_dpp v21, v8, v5 row_newbcast:5 row_mask:0xf bank_mask:0xf
  v_and_b32_dpp v22, v8, v6 row_newbcast:5 row_mask:0xf bank_mask:0xf
  v_and_b32_dpp v23, v8, v7 row_newbcast:5 row_mask:0xf bank_mask:0xf
  s_waitcnt vmcnt(4)
  buffer_load_dwordx4 v[100:103], v3, s[32:35], s46 offen nt
  s_add_u32 s46, s46, 32768
  v_mfma_f32_16x16x32_bf16 v[24:27], v[16:19], v[80:83], v[24:27]
  v_and_b32_dpp v16, v8, v4 row_newbcast:6 row_mask:0xf bank_mask:0xf
  v_and_b32_dpp v17, v8, v5 row_newbcast:6 row_mask:0xf bank_mask:0xf
  v_and_b32_dpp v18, v8, v6 row_newbcast:6 row_mask:0xf bank_mask:0xf
  v_and_b32_dpp v19, v8, v7 row_newbcast:6 row_mask:0xf bank_mask:0xf
  s_waitcnt vmcnt(4)
  buffer_load_dwordx4 v[104:107], v3, s[32:35], s46 offen nt
  s_add_u32 s46, s46, 32768
  v_mfma_f32_16x16x32_bf16 v[24:27], v[20:23], v[84:87], v[24:27]
  v_and_b32_dpp v20, v8, v4 row_newbcast:7 row_mask:0xf bank_mask:0xf
  v_and_b32_dpp v21, v8, v5 row_newbcast:7 row_mask:0xf bank_mask:0xf
  v_and_b32_dpp v22, v8, v6 row_newbcast:7 row_mask:0xf bank_mask:0xf
  v_and_b32_dpp v23, v8, v7 row_newbcast:7 row_mask:0xf bank_mask:0xf
  s_waitcnt vmcnt(4)
  buffer_load_dwordx4 v[108:111], v3, s[32:35], s46 offen nt
  s_add_u32 s46, s46, 32768
  v_mfma_f32_16x16x32_bf16 v[24:27], v[16:19], v[88:91], v[24:27]
  v_and_b32_dpp v16, v8, v4 row_newbcast:8 row_mask:0xf bank_mask:0xf
  v_and_b32_dpp v17, v8, v5 row_newbcast:8 row_mask:0xf bank_mask:0xf
  v_and_b32_dpp v18, v8, v6 row_newbcast:8 row_mask:0xf bank_mask:0xf
  v_and_b32_dpp v19, v8, v7 row_newbcast:8 row_mask:0xf bank_mask:0xf
  s_waitcnt vmcnt(4)
  buffer_load_dwordx4 v[112:115], v3, s[32:35], s46 offen nt
  s_add_u32 s46, s46, 32768
  v_mfma_f32_16x16x32_bf16 v[24:27], v[20:23], v[92:95], v[24:27]
  v_and_b32_dpp v20, v8, v4 row_newbcast:9 row_mask:0xf bank_mask:0xf
  v_and_b32_dpp v21, v8, v5 row_newbcast:9 row_mask:0xf bank_mask:0xf
  v_and_b32_dpp v22, v8, v6 row_newbcast:9 row_mask:0xf bank_mask:0xf
  v_and_b32_dpp v23, v8, v7 row_newbcast:9 row_mask:0xf bank_mask:0xf
  s_waitcnt vmcnt(4)
  buffer_load_dwordx4 v[116:119], v3, s[32:35], s46 offen nt
  s_add_u32 s46, s46, 32768
  v_mfma_f32_16x16x32_bf16 v[24:27], v[16:19], v[96:99], v[24:27]
  v_and_b32_dpp v16, v8, v4 row_newbcast:10 row_mask:0xf bank_mask:0xf
  v_and_b32_dpp v17, v8, v5 row_newbcast:10 row_mask:0xf bank_mask:0xf
  v_and_b32_dpp v18, v8, v6 row_newbcast:10 row_mask:0xf bank_mask:0xf
  v_and_b32_dpp v19, v8, v7 row_newbcast:10 row_mask:0xf bank_mask:0xf
  s_waitcnt vmcnt(4)
  buffer_load_dwordx4 v[120:123], v3, s[32:35], s46 offen nt
  s_add_u32 s46, s46, 32768
  v_mfma_f32_16x16x32_bf16 v[24:27], v[20:23], v[100:103], v[24:27]
  v_and_b32_dpp v20, v8, v4 row_newbcast:11 row_mask:0xf bank_mask:0xf
  v_and_b32_dpp v21, v8, v5 row_newbcast:11 row_mask:0xf bank_mask:0xf
  v_and_b32_dpp v22, v8, v6 row_newbcast:11 row_mask:0xf bank_mask:0xf
  v_and_b32_dpp v23, v8, v7 row_newbcast:11 row_mask:0xf bank_mask:0xf
  s_waitcnt vmcnt(4)
  buffer_load_dwordx4 v[124:127], v3, s[32:35], s46 offen nt
  s_add_u32 s46, s46, 32768
  v_mfma_f32_16x16x32_bf16 v[24:27], v[16:19], v[104:107], v[24:27]
  v_and_b32_dpp v16, v8, v4 row_newbcast:12 row_mask:0xf bank_mask:0xf
  v_and_b32_dpp v17, v8, v5 row_newbcast:12 row_mask:0xf bank_mask:0xf
  v_and_b32_dpp v18, v8, v6 row_newbcast:12 row_mask:0xf bank_mask:0xf
  v_and_b32_dpp v19, v8, v7 row_newbcast:12 row_mask:0xf bank_mask:0xf
  s_waitcnt vmcnt(4)
  buffer_load_dwordx4 v[128:131], v3, s[32:35], s46 offen nt
  s_add_u32 s46, s46, 32768
  v_mfma_f32_16x16x32_bf16 v[24:27], v[20:23], v[108:111], v[24:27]
  v_and_b32_dpp v20, v8, v4 row_newbcast:13 row_mask:0xf bank_mask:0xf
  v_and_b32_dpp v21, v8, v5 row_newbcast:13 row_mask:0xf bank_mask:0xf
  v_and_b32_dpp v22, v8, v6 row_newbcast:13 row_mask:0xf bank_mask:0xf
  v_and_b32_dpp v23, v8, v7 row_newbcast:13 row_mask:0xf bank_mask:0xf
  s_waitcnt vmcnt(4)
  buffer_load_dwordx4 v[132:135], v3, s[32:35], s46 offen nt
  s_add_u32 s46, s46, 32768
  v_mfma_f32_16x16x32_bf16 v[24:27], v[16:19], v[112:115], v[24:27]
  v_and_b32_dpp v16, v8, v4 row_newbcast:14 row_mask:0xf bank_mask:0xf
  v_and_b32_dpp v17, v8, v5 row_newbcast:14 row_mask:0xf bank_mask:0xf
  v_and_b32_dpp v18, v8, v6 row_newbcast:14 row_mask:0xf bank_mask:0xf
  v_and_b32_dpp v19, v8, v7 row_newbcast:14 row_mask:0xf bank_mask:0xf
  s_waitcnt vmcnt(4)
  buffer_load_dwordx4 v[136:139], v3, s[32:35], s46 offen nt
  s_add_u32 s46, s46, 32768
  v_mfma_f32_16x16x32_bf16 v[24:27], v[20:23], v[116:119], v[24:27]
  v_and_b32_dpp v20, v8, v4 row_newbcast:15 row_mask:0xf bank_mask:0xf
  v_and_b32_dpp v21, v8, v5 row_newbcast:15 row_mask:0xf bank_mask:0xf
  v_and_b32_dpp v22, v8, v6 row_newbcast:15 row_mask:0xf bank_mask:0xf
  v_and_b32_dpp v23, v8, v7 row_newbcast:15 row_mask:0xf bank_mask:0xf
  s_waitcnt vmcnt(4)
  buffer_load_dwordx4 v[140:143], v3, s[32:35], s46 offen nt
  s_add_u32 s46, s46, 32768
  v_mfma_f32_16x16x32_bf16 v[24:27], v[16:19], v[120:123], v[24:27]
  v_and_b32_dpp v16, v9, v4 row_newbcast:0 row_mask:0xf bank_mask:0xf
  v_and_b32_dpp v17, v9, v5 row_newbcast:0 row_mask:0xf bank_mask:0xf
  v_and_b32_dpp v18, v9, v6 row_newbcast:0 row_mask:0xf bank_mask:0xf
  v_and_b32_dpp v19, v9, v7 row_newbcast:0 row_mask:0xf bank_mask:0xf
  s_waitcnt vmcnt(4)
  buffer_load_dwordx4 v[144:147], v3, s[32:35], s46 offen nt
  s_add_u32 s46, s46, 32768
  v_mfma_f32_16x16x32_bf16 v[24:27], v[20:23], v[124:127], v[24:27]
  v_and_b32_dpp v20, v9, v4 row_newbcast:1 row_mask:0xf bank_mask:0xf
  v_and_b32_dpp v21, v9, v5 row_newbcast:1 row_mask:0xf bank_mask:0xf
  v_and_b32_dpp v22, v9, v6 row_newbcast:1 row_mask:0xf bank_mask:0xf
  v_and_b32_dpp v23, v9, v7 row_newbcast:1 row_mask:0xf bank_mask:0xf
  s_waitcnt vmcnt(4)
  buffer_load_dwordx4 v[148:151], v3, s[32:35], s46 offen nt
  s_add_u32 s46, s46, 32768
  v_mfma_f32_16x16x32_bf16 v[24:27], v[16:19], v[128:131], v[24:27]
  v_and_b32_dpp v16, v9, v4 row_newbcast:2 row_mask:0xf bank_mask:0xf
  v_and_b32_dpp v17, v9, v5 row_newbcast:2 row_mask:0xf bank_mask:0xf
  v_and_b32_dpp v18, v9, v6 row_newbcast:2 row_mask:0xf bank_mask:0xf
  v_and_b32_dpp v19, v9, v7 row_newbcast:2 row_mask:0xf bank_mask:0xf
  s_waitcnt vmcnt(4)
  buffer_load_dwordx4 v[152:155], v3, s[32:35], s46 offen nt
  s_add_u32 s46, s46, 32768
  v_mfma_f32_16x16x32_bf16 v[24:27], v[20:23], v[132:135], v[24:27]
  v_and_b32_dpp v20, v9, v4 row_newbcast:3 row_mask:0xf bank_mask:0xf
  v_and_b32_dpp v21, v9, v5 row_newbcast:3 row_mask:0xf bank_mask:0xf
  v_and_b32_dpp v22, v9, v6 row_newbcast:3 row_mask:0xf bank_mask:0xf
  v_and_b32_dpp v23, v9, v7 row_newbcast:3 row_mask:0xf bank_mask:0xf
  s_waitcnt vmcnt(4)
  buffer_load_dwordx4 v[156:159], v3, s[32:35], s46 offen nt
  s_add_u32 s46, s46, 32768
  v_mfma_f32_16x16x32_bf16 v[24:27], v[16:19], v[136:139], v[24:27]
  v_and_b32_dpp v16, v9, v4 row_newbcast:4 row_mask:0xf bank_mask:0xf
  v_and_b32_dpp v17, v9, v5 row_newbcast:4 row_mask:0xf bank_mask:0xf
  v_and_b32_dpp v18, v9, v6 row_newbcast:4 row_mask:0xf bank_mask:0xf
  v_and_b32_dpp v19, v9, v7 row_newbcast:4 row_mask:0xf bank_mask:0xf
  s_waitcnt vmcnt(4)
  buffer_load_dwordx4 v[160:163], v3, s[32:35], s46 offen nt
  s_add_u32 s46, s46, 32768
  v_mfma_f32_16x16x32_bf16 v[24:27], v[20:23], v[140:143], v[24:27]
  v_and_b32_dpp v20, v9, v4 row_newbcast:5 row_mask:0xf bank_mask:0xf
  v_and_b32_dpp v21, v9, v5 row_newbcast:5 row_mask:0xf bank_mask:0xf
  v_and_b32_dpp v22, v9, v6 row_newbcast:5 row_mask:0xf bank_mask:0xf
  v_and_b32_dpp v23, v9, v7 row_newbcast:5 row_mask:0xf bank_mask:0xf
  s_waitcnt vmcnt(4)
  buffer_load_dwordx4 v[164:167], v3, s[32:35], s46 offen nt
  s_add_u32 s46, s46, 32768
  v_mfma_f32_16x16x32_bf16 v[24:27], v[16:19], v[144:147], v[24:27]
  v_and_b32_dpp v16, v9, v4 row_newbcast:6 row_mask:0xf bank_mask:0xf
  v_and_b32_dpp v17, v9, v5 row_newbcast:6 row_mask:0xf bank_mask:0xf
  v_and_b32_dpp v18, v9, v6 row_newbcast:6 row_mask:0xf bank_mask:0xf
  v_and_b32_dpp v19, v9, v7 row_newbcast:6 row_mask:0xf bank_mask:0xf
  s_waitcnt vmcnt(4)
  buffer_load_dwordx4 v[168:171], v3, s[32:35], s46 offen nt
  s_add_u32 s46, s46, 32768
  v_mfma_f32_16x16x32_bf16 v[24:27], v[20:23], v[148:151], v[24:27]
  v_and_b32_dpp v20, v9, v4 row_newbcast:7 row_mask:0xf bank_mask:0xf
  v_and_b32_dpp v21, v9, v5 row_newbcast:7 row_mask:0xf bank_mask:0xf
  v_and_b32_dpp v22, v9, v6 row_newbcast:7 row_mask:0xf bank_mask:0xf
  v_and_b32_dpp v23, v9, v7 row_newbcast:7 row_mask:0xf bank_mask:0xf
  s_waitcnt vmcnt(4)
  buffer_load_dwordx4 v[172:175], v3, s[32:35], s46 offen nt
  s_add_u32 s46, s46, 32768
  v_mfma_f32_16x16x32_bf16 v[24:27], v[16:19], v[152:155], v[24:27]
  v_and_b32_dpp v16, v9, v4 row_newbcast:8 row_mask:0xf bank_mask:0xf
  v_and_b32_dpp v17, v9, v5 row_newbcast:8 row_mask:0xf bank_mask:0xf
  v_and_b32_dpp v18, v9, v6 row_newbcast:8 row_mask:0xf bank_mask:0xf
  v_and_b32_dpp v19, v9, v7 row_newbcast:8 row_mask:0xf bank_mask:0xf
  s_waitcnt vmcnt(4)
  buffer_load_dwordx4 v[176:179], v3, s[32:35], s46 offen nt
  s_add_u32 s46, s46, 32768
  v_mfma_f32_16x16x32_bf16 v[24:27], v[20:23], v[156:159], v[24:27]
  v_and_b32_dpp v20, v9, v4 row_newbcast:9 row_mask:0xf bank_mask:0xf
  v_and_b32_dpp v21, v9, v5 row_newbcast:9 row_mask:0xf bank_mask:0xf
  v_and_b32_dpp v22, v9, v6 row_newbcast:9 row_mask:0xf bank_mask:0xf
  v_and_b32_dpp v23, v9, v7 row_newbcast:9 row_mask:0xf bank_mask:0xf
  s_waitcnt vmcnt(4)
  buffer_load_dwordx4 v[180:183], v3, s[32:35], s46 offen nt
  s_add_u32 s46, s46, 32768
  v_mfma_f32_16x16x32_bf16 v[24:27], v[16:19], v[160:163], v[24:27]
  v_and_b32_dpp v16, v9, v4 row_newbcast:10 row_mask:0xf bank_mask:0xf
  v_and_b32_dpp v17, v9, v5 row_newbcast:10 row_mask:0xf bank_mask:0xf
  v_and_b32_dpp v18, v9, v6 row_newbcast:10 row_mask:0xf bank_mask:0xf
  v_and_b32_dpp v19, v9, v7 row_newbcast:10 row_mask:0xf bank_mask:0xf
  s_waitcnt vmcnt(4)
  buffer_load_dwordx4 v[184:187], v3, s[32:35], s46 offen nt
  s_add_u32 s46, s46, 32768
  v_mfma_f32_16x16x32_bf16 v[24:27], v[20:23], v[164:167], v[24:27]
  v_and_b32_dpp v20, v9, v4 row_newbcast:11 row_mask:0xf bank_mask:0xf
  v_and_b32_dpp v21, v9, v5 row_newbcast:11 row_mask:0xf bank_mask:0xf
  v_and_b32_dpp v22, v9, v6 row_newbcast:11 row_mask:0xf bank_mask:0xf
  v_and_b32_dpp v23, v9, v7 row_newbcast:11 row_mask:0xf bank_mask:0xf
  s_waitcnt vmcnt(4)
  buffer_load_dwordx4 v[188:191], v3, s[32:35], s46 offen nt
  s_add_u32 s46, s46, 32768
  v_mfma_f32_16x16x32_bf16 v[24:27], v[16:19], v[168:171], v[24:27]
  v_and_b32_dpp v16, v9, v4 row_newbcast:12 row_mask:0xf bank_mask:0xf
  v_and_b32_dpp v17, v9, v5 row_newbcast:12 row_mask:0xf bank_mask:0xf
  v_and_b32_dpp v18, v9, v6 row_newbcast:12 row_mask:0xf bank_mask:0xf
  v_and_b32_dpp v19, v9, v7 row_newbcast:12 row_mask:0xf bank_mask:0xf
  s_waitcnt vmcnt(4)
  buffer_load_dwordx4 v[192:195], v3, s[32:35], s46 offen nt
  s_add_u32 s46, s46, 32768
  v_mfma_f32_16x16x32_bf16 v[24:27], v[20:23], v[172:175], v[24:27]
  v_and_b32_dpp v20, v9, v4 row_newbcast:13 row_mask:0xf bank_mask:0xf
  v_and_b32_dpp v21, v9, v5 row_newbcast:13 row_mask:0xf bank_mask:0xf
  v_and_b32_dpp v22, v9, v6 row_newbcast:13 row_mask:0xf bank_mask:0xf
  v_and_b32_dpp v23, v9, v7 row_newbcast:13 row_mask:0xf bank_mask:0xf
  s_waitcnt vmcnt(4)
  buffer_load_dwordx4 v[196:199], v3, s[32:35], s46 offen nt
  s_add_u32 s46, s46, 32768
  v_mfma_f32_16x16x32_bf16 v[24:27], v[16:19], v[176:179], v[24:27]
  v_and_b32_dpp v16, v9, v4 row_newbcast:14 row_mask:0xf bank_mask:0xf
  v_and_b32_dpp v17, v9, v5 row_newbcast:14 row_mask:0xf bank_mask:0xf
  v_and_b32_dpp v18, v9, v6 row_newbcast:14 row_mask:0xf bank_mask:0xf
  v_and_b32_dpp v19, v9, v7 row_newbcast:14 row_mask:0xf bank_mask:0xf
  s_waitcnt vmcnt(4)
  buffer_load_dwordx4 v[200:203], v3, s[32:35], s46 offen nt
  s_add_u32 s46, s46, 32768
  v_mfma_f32_16x16x32_bf16 v[24:27], v[20:23], v[180:183], v[24:27]
  v_and_b32_dpp v20, v9, v4 row_newbcast:15 row_mask:0xf bank_mask:0xf
  v_and_b32_dpp v21, v9, v5 row_newbcast:15 row_mask:0xf bank_mask:0xf
  v_and_b32_dpp v22, v9, v6 row_newbcast:15 row_mask:0xf bank_mask:0xf
  v_and_b32_dpp v23, v9, v7 row_newbcast:15 row_mask:0xf bank_mask:0xf
  s_waitcnt vmcnt(4)
  buffer_load_dwordx4 v[204:207], v3, s[32:35], s46 offen nt
  v_mfma_f32_16x16x32_bf16 v[24:27], v[16:19], v[184:187], v[24:27]
  v_and_b32_dpp v16, v10, v4 row_newbcast:0 row_mask:0xf bank_mask:0xf
  v_and_b32_dpp v17, v10, v5 row_newbcast:0 row_mask:0xf bank_mask:0xf
  v_and_b32_dpp v18, v10, v6 row_newbcast:0 row_mask:0xf bank_mask:0xf
  v_and_b32_dpp v19, v10, v7 row_newbcast:0 row_mask:0xf bank_mask:0xf
  s_waitcnt vmcnt(4)
  v_mfma_f32_16x16x32_bf16 v[24:27], v[20:23], v[188:191], v[24:27]
  v_and_b32_dpp v20, v10, v4 row_newbcast:1 row_mask:0xf bank_mask:0xf
  v_and_b32_dpp v21, v10, v5 row_newbcast:1 row_mask:0xf bank_mask:0xf
  v_and_b32_dpp v22, v10, v6 row_newbcast:1 row_mask:0xf bank_mask:0xf
  v_and_b32_dpp v23, v10, v7 row_newbcast:1 row_mask:0xf bank_mask:0xf
  s_waitcnt vmcnt(3)
  v_mfma_f32_16x16x32_bf16 v[24:27], v[16:19], v[192:195], v[24:27]
  v_and_b32_dpp v16, v10, v4 row_newbcast:2 row_mask:0xf bank_mask:0xf
  v_and_b32_dpp v17, v10, v5 row_newbcast:2 row_mask:0xf bank_mask:0xf
  v_and_b32_dpp v18, v10, v6 row_newbcast:2 row_mask:0xf bank_mask:0xf
  v_and_b32_dpp v19, v10, v7 row_newbcast:2 row_mask:0xf bank_mask:0xf
  s_waitcnt vmcnt(2)
  v_mfma_f32_16x16x32_bf16 v[24:27], v[20:23], v[196:199], v[24:27]
  v_and_b32_dpp v20, v10, v4 row_newbcast:3 row_mask:0xf bank_mask:0xf
  v_and_b32_dpp v21, v10, v5 row_newbcast:3 row_mask:0xf bank_mask:0xf
  v_and_b32_dpp v22, v10, v6 row_newbcast:3 row_mask:0xf bank_mask:0xf
  v_and_b32_dpp v23, v10, v7 row_newbcast:3 row_mask:0xf bank_mask:0xf
  s_waitcnt vmcnt(1)
  v_mfma_f32_16x16x32_bf16 v[24:27], v[16:19], v[200:203], v[24:27]
  s_nop 0
  s_waitcnt vmcnt(0)
  v_mfma_f32_16x16x32_bf16 v[24:27], v[20:23], v[204:207], v[24:27]
  v_and_b32 v12, 1, v1
  v_lshlrev_b32 v12, 4, v12
  v_lshl_add_u32 v12, v2, 5, v12
  s_lshl_b32 s45, s44, 9
  s_add_u32 s45, s45, 123136
  v_add_u32 v13, s45, v12
  v_mov_b32 v14, 122880
  v_mov_b32 v15, 1
  s_nop 1
  ds_write_b128 v13, v[24:27]
  s_mov_b64 exec, 1
  ds_add_u32 v14, v15 offset:32
  s_mov_b64 exec, -1
  s_mov_b32 s40, s22
  s_and_b32 s41, s23, 0xffff
  s_mov_b32 s42, 1152
  s_mov_b32 s43, 0x20000
  v_lshlrev_b32 v11, 4, v0
  s_mul_i32 s45, s44, 288
  buffer_load_dwordx4 v[28:31], v11, s[36:39], 0 offen
  buffer_load_dwordx4 v[32:35], v11, s[36:39], 0 offen offset:1024
  buffer_load_dwordx4 v[36:39], v11, s[40:43], 0 offen
  buffer_load_dwordx4 v[40:43], v11, s[40:43], 0 offen offset:1024
  buffer_load_dwordx4 v[48:51], v11, s[36:39], s45 offen
  s_add_u32 s45, s45, 125184
  v_add_u32 v13, s45, v11
  s_waitcnt vmcnt(0)
  s_mov_b64 exec, 0x3ffff
  ds_write_b128 v13, v[48:51]
  s_mov_b64 exec, -1
  v_dot2_f32_bf16 v44, v28, v36, 0
  v_dot2_f32_bf16 v44, v29, v37, v44
  v_dot2_f32_bf16 v44, v30, v38, v44
  v_dot2_f32_bf16 v44, v31, v39, v44
  v_dot2_f32_bf16 v44, v32, v40, v44
  v_dot2_f32_bf16 v44, v33, v41, v44
  v_dot2_f32_bf16 v44, v34, v42, v44
  v_dot2_f32_bf16 v44, v35, v43, v44
  s_nop 2
  v_add_f32_dpp v44, v44, v44 row_ror:1 row_mask:0xf bank_mask:0xf
  s_nop 1
  v_add_f32_dpp v44, v44, v44 row_ror:2 row_mask:0xf bank_mask:0xf
  s_nop 1
  v_add_f32_dpp v44, v44, v44 row_ror:4 row_mask:0xf bank_mask:0xf
  s_nop 1
  v_add_f32_dpp v44, v44, v44 row_ror:8 row_mask:0xf bank_mask:0xf
  s_nop 1
  v_mov_b32 v45, v44
  s_nop 1
  v_permlane16_swap_b32 v45, v44
  v_add_f32 v44, v44, v45
  v_mov_b32 v45, v44
  s_nop 1
  v_permlane32_swap_b32 v45, v44
  v_add_f32 v44, v44, v45
  v_mul_f32 v45, 0x3fb8aa3b, v44
  v_mul_f32 v44, 0xbfb8aa3b, v44
  v_exp_f32 v44, v44
  v_exp_f32 v45, v45
  s_nop 0
  v_add_f32 v44, 1.0, v44
  v_add_f32 v45, 1.0, v45
  v_rcp_f32 v44, v44
  v_rcp_f32 v45, v45
  v_mul_u32_u24 v3, 2304, v1
  v_lshl_add_u32 v3, v2, 4, v3
  s_mov_b32 s32, s16
  s_and_b32 s33, s17, 0xffff
  s_mov_b32 s34, 5308416
  s_mov_b32 s35, 0x20000
  s_mov_b32 s40, s18
  s_and_b32 s41, s19, 0xffff
  s_mov_b32 s42, 5308416
  s_mov_b32 s43, 0x20000
  v_mul_u32_u24 v8, 57, v0
  v_lshrrev_b32 v8, 10, v8
  v_mul_u32_u24 v9, 18, v8
  v_sub_u32 v9, v0, v9
  v_mul_u32_u24 v10, 9216, v8
  v_lshl_add_u32 v10, v9, 4, v10
  v_bfrev_b32 v11, 1
  v_cmp_gt_u32 vcc, 54, v0
  s_nop 1
  v_cndmask_b32 v10, v11, v10, vcc
  v_lshl_add_u32 v11, v8, 1, s45
  s_mul_i32 s46, s44, 1327104
  s_mul_i32 s47, s31, 288
  s_add_u32 s46, s46, s47
  v_mov_b32 v16, 0
  v_mov_b32 v17, 0
  v_mov_b32 v18, 0
  v_mov_b32 v19, 0
  v_mov_b32 v20, 0
  v_mov_b32 v21, 0
  v_mov_b32 v22, 0
  v_mov_b32 v23, 0
  v_mov_b32 v24, 0
  v_mov_b32 v25, 0
  v_mov_b32 v26, 0
  v_mov_b32 v27, 0
  v_mov_b32 v28, 0
  v_mov_b32 v29, 0
  v_mov_b32 v30, 0
  v_mov_b32 v31, 0
  s_mov_b32 s49, 48
L_f1:
  buffer_load_dwordx4 v[64:67], v10, s[32:35], s46 offen
  buffer_load_dwordx4 v[68:71], v10, s[40:43], s46 offen
  ds_read_u16 v32, v11
  s_add_u32 s46, s46, 27648
  v_add_u32 v11, 6, v11
  s_sub_u32 s49, s49, 1
  s_waitcnt vmcnt(0) lgkmcnt(0)
  v_lshlrev_b32 v33, 16, v32
  v_dot2_f32_bf16 v16, v64, v32, v16
  v_dot2_f32_bf16 v17, v64, v33, v17
  v_dot2_f32_bf16 v18, v65, v32, v18
  v_dot2_f32_bf16 v19, v65, v33, v19
  v_dot2_f32_bf16 v20, v66, v32, v20
  v_dot2_f32_bf16 v21, v66, v33, v21
  v_dot2_f32_bf16 v22, v67, v32, v22
  v_dot2_f32_bf16 v23, v67, v33, v23
  v_dot2_f32_bf16 v24, v68, v32, v24
  v_dot2_f32_bf16 v25, v68, v33, v25
  v_dot2_f32_bf16 v26, v69, v32, v26
  v_dot2_f32_bf16 v27, v69, v33, v27
  v_dot2_f32_bf16 v28, v70, v32, v28
  v_dot2_f32_bf16 v29, v70, v33, v29
  v_dot2_f32_bf16 v30, v71, v32, v30
  v_dot2_f32_bf16 v31, v71, v33, v31
  s_cmp_lg_u32 s49, 0
  s_cbranch_scc1 L_f1
  v_lshlrev_b32 v10, 2, v0
  v_add_u32 v11, 144, v10
  v_add_u32 v10, 72, v10
  ds_bpermute_b32 v64, v10, v16
  ds_bpermute_b32 v65, v10, v17
  ds_bpermute_b32 v66, v10, v18
  ds_bpermute_b32 v67, v10, v19
  ds_bpermute_b32 v68, v10, v20
  ds_bpermute_b32 v69, v10, v21
  ds_bpermute_b32 v70, v10, v22
  ds_bpermute_b32 v71, v10, v23
  s_waitcnt lgkmcnt(0)
  ds_bpermute_b32 v72, v11, v16
  ds_bpermute_b32 v73, v11, v17
  ds_bpermute_b32 v74, v11, v18
  ds_bpermute_b32 v75, v11, v19
  ds_bpermute_b32 v76, v11, v20
  ds_bpermute_b32 v77, v11, v21
  ds_bpermute_b32 v78, v11, v22
  ds_bpermute_b32 v79, v11, v23
  v_add_f32 v64, v64, v16
  v_add_f32 v65, v65, v17
  v_add_f32 v66, v66, v18
  v_add_f32 v67, v67, v19
  v_add_f32 v68, v68, v20
  v_add_f32 v69, v69, v21
  v_add_f32 v70, v70, v22
  v_add_f32 v71, v71, v23
  s_waitcnt lgkmcnt(0)
  v_add_f32 v16, v64, v72
  v_add_f32 v17, v65, v73
  v_add_f32 v18, v66, v74
  v_add_f32 v19, v67, v75
  v_add_f32 v20, v68, v76
  v_add_f32 v21, v69, v77
  v_add_f32 v22, v70, v78
  v_add_f32 v23, v71, v79
  ds_bpermute_b32 v64, v10, v24
  ds_bpermute_b32 v65, v10, v25
  ds_bpermute_b32 v66, v10, v26
  ds_bpermute_b32 v67, v10, v27
  ds_bpermute_b32 v68, v10, v28
  ds_bpermute_b32 v69, v10, v29
  ds_bpermute_b32 v70, v10, v30
  ds_bpermute_b32 v71, v10, v31
  s_waitcnt lgkmcnt(0)
  ds_bpermute_b32 v72, v11, v24
  ds_bpermute_b32 v73, v11, v25
  ds_bpermute_b32 v74, v11, v26
  ds_bpermute_b32 v75, v11, v27
  ds_bpermute_b32 v76, v11, v28
  ds_bpermute_b32 v77, v11, v29
  ds_bpermute_b32 v78, v11, v30
  ds_bpermute_b32 v79, v11, v31
  v_add_f32 v64, v64, v24
  v_add_f32 v65, v65, v25
  v_add_f32 v66, v66, v26
  v_add_f32 v67, v67, v27
  v_add_f32 v68, v68, v28
  v_add_f32 v69, v69, v29
  v_add_f32 v70, v70, v30
  v_add_f32 v71, v71, v31
  s_waitcnt lgkmcnt(0)
  v_add_f32 v24, v64, v72
  v_add_f32 v25, v65, v73
  v_add_f32 v26, v66, v74
  v_add_f32 v27, v67, v75
  v_add_f32 v28, v68, v76
  v_add_f32 v29, v69, v77
  v_add_f32 v30, v70, v78
  v_add_f32 v31, v71, v79
  s_mul_i32 s45, s44, 1152
  s_add_u32 s45, s45, 126464
  v_lshl_add_u32 v8, v0, 5, s45
  s_mov_b64 exec, 0x3ffff
  ds_write_b128 v8, v[16:19]
  ds_write_b128 v8, v[20:23] offset:16
  ds_write_b128 v8, v[24:27] offset:576
  ds_write_b128 v8, v[28:31] offset:592
  s_mov_b64 exec, 1
  ds_add_u32 v14, v15 offset:36
  s_mov_b64 exec, -1
  s_mul_i32 s47, s44, 5
  s_min_u32 s47, s47, 14
  s_lshl_b32 s45, s47, 5
  s_add_u32 s45, s45, 126464
  v_lshrrev_b32 v8, 3, v0
  v_lshl_add_u32 v8, v8, 2, s45
  s_mov_b32 s32, s20
  s_and_b32 s33, s21, 0xffff
  s_mov_b32 s34, 5308416
  s_mov_b32 s35, 0x20000
  s_mul_i32 s46, s31, 165888
  s_mul_i32 s47, s47, 9216
  s_add_u32 s46, s46, s47
L_fsync:
  ds_read_b32 v13, v14 offset:36
  s_waitcnt lgkmcnt(0)
  v_readfirstlane_b32 s45, v13
  s_cmp_ge_u32 s45, 4
  s_cbranch_scc1 L_fsync_ok
  s_sleep 2
  s_branch L_fsync
L_fsync_ok:
  ds_read2_b32 v[64:65], v8 offset0:0 offset1:144
  ds_read2_b32 v[66:67], v8 offset0:8 offset1:152
  ds_read2_b32 v[68:69], v8 offset0:16 offset1:160
  ds_read2_b32 v[70:71], v8 offset0:24 offset1:168
  ds_read2_b32 v[72:73], v8 offset0:32 offset1:176
  v_add_u32 v8, 1152, v8
  ds_read2_b32 v[74:75], v8 offset0:0 offset1:144
  ds_read2_b32 v[76:77], v8 offset0:8 offset1:152
  ds_read2_b32 v[78:79], v8 offset0:16 offset1:160
  ds_read2_b32 v[80:81], v8 offset0:24 offset1:168
  ds_read2_b32 v[82:83], v8 offset0:32 offset1:176
  v_add_u32 v8, 1152, v8
  s_waitcnt lgkmcnt(0)
  ds_read2_b32 v[84:85], v8 offset0:0 offset1:144
  ds_read2_b32 v[86:87], v8 offset0:8 offset1:152
  ds_read2_b32 v[88:89], v8 offset0:16 offset1:160
  ds_read2_b32 v[90:91], v8 offset0:24 offset1:168
  ds_read2_b32 v[92:93], v8 offset0:32 offset1:176
  v_add_u32 v8, 1152, v8
  ds_read2_b32 v[94:95], v8 offset0:0 offset1:144
  ds_read2_b32 v[96:97], v8 offset0:8 offset1:152
  ds_read2_b32 v[98:99], v8 offset0:16 offset1:160
  ds_read2_b32 v[100:101], v8 offset0:24 offset1:168
  ds_read2_b32 v[102:103], v8 offset0:32 offset1:176
  s_waitcnt lgkmcnt(0)
  v_add_f32 v64, v64, v74
  v_add_f32 v65, v65, v75
  v_add_f32 v66, v66, v76
  v_add_f32 v67, v67, v77
  v_add_f32 v68, v68, v78
  v_add_f32 v69, v69, v79
  v_add_f32 v70, v70, v80
  v_add_f32 v71, v71, v81
  v_add_f32 v72, v72, v82
  v_add_f32 v73, v73, v83
  v_add_f32 v64, v64, v84
  v_add_f32 v65, v65, v85
  v_add_f32 v66, v66, v86
  v_add_f32 v67, v67, v87
  v_add_f32 v68, v68, v88
  v_add_f32 v69, v69, v89
  v_add_f32 v70, v70, v90
  v_add_f32 v71, v71, v91
  v_add_f32 v72, v72, v92
  v_add_f32 v73, v73, v93
  v_add_f32 v64, v64, v94
  v_add_f32 v65, v65, v95
  v_add_f32 v66, v66, v96
  v_add_f32 v67, v67, v97
  v_add_f32 v68, v68, v98
  v_add_f32 v69, v69, v99
  v_add_f32 v70, v70, v100
  v_add_f32 v71, v71, v101
  v_add_f32 v72, v72, v102
  v_add_f32 v73, v73, v103
  v_mul_f32 v16, 0xbfb8aa3b, v64
  v_mul_f32 v17, 0xbfb8aa3b, v66
  v_mul_f32 v18, 0xbfb8aa3b, v68
  v_mul_f32 v19, 0xbfb8aa3b, v70
  v_mul_f32 v20, 0xbfb8aa3b, v72
  v_exp_f32 v16, v16
  v_exp_f32 v17, v17
  v_exp_f32 v18, v18
  v_exp_f32 v19, v19
  v_exp_f32 v20, v20
  v_mul_f32 v65, v65, v45
  v_mul_f32 v67, v67, v45
  v_mul_f32 v69, v69, v45
  v_mul_f32 v71, v71, v45
  v_mul_f32 v73, v73, v45
  v_add_f32 v16, 1.0, v16
  v_add_f32 v17, 1.0, v17
  v_add_f32 v18, 1.0, v18
  v_add_f32 v19, 1.0, v19
  v_add_f32 v20, 1.0, v20
  v_rcp_f32 v16, v16
  v_rcp_f32 v17, v17
  v_rcp_f32 v18, v18
  v_rcp_f32 v19, v19
  v_rcp_f32 v20, v20
  s_nop 0
  v_mul_f32 v16, v16, v64
  v_mul_f32 v17, v17, v66
  v_mul_f32 v18, v18, v68
  v_mul_f32 v19, v19, v70
  v_mul_f32 v20, v20, v72
  v_mul_f32 v16, v16, v65
  v_mul_f32 v17, v17, v67
  v_mul_f32 v18, v18, v69
  v_mul_f32 v19, v19, v71
  v_mul_f32 v20, v20, v73
  v_cvt_pk_bf16_f32 v16, v16, v16
  v_cvt_pk_bf16_f32 v17, v17, v17
  v_cvt_pk_bf16_f32 v18, v18, v18
  v_cvt_pk_bf16_f32 v19, v19, v19
  v_cvt_pk_bf16_f32 v20, v20, v20
  v_and_b32 v13, 8, v0
  v_cmp_eq_u32 vcc, 0, v13
  s_nop 1
  v_cndmask_b32 v228, 0, v4, vcc
  v_cndmask_b32 v232, v4, 0, vcc
  v_cndmask_b32 v229, 0, v5, vcc
  v_cndmask_b32 v233, v5, 0, vcc
  v_cndmask_b32 v230, 0, v6, vcc
  v_cndmask_b32 v234, v6, 0, vcc
  v_cndmask_b32 v231, 0, v7, vcc
  v_cndmask_b32 v235, v7, 0, vcc
  s_waitcnt vmcnt(1)
  buffer_load_dwordx4 v[64:67], v3, s[32:35], s46 offen offset:0
  s_waitcnt vmcnt(1)
  buffer_load_dwordx4 v[68:71], v3, s[32:35], s46 offen offset:256
  s_waitcnt vmcnt(1)
  buffer_load_dwordx4 v[72:75], v3, s[32:35], s46 offen offset:512
  s_waitcnt vmcnt(1)
  buffer_load_dwordx4 v[76:79], v3, s[32:35], s46 offen offset:768
  s_waitcnt vmcnt(1)
  buffer_load_dwordx4 v[80:83], v3, s[32:35], s46 offen offset:1024
  s_waitcnt vmcnt(1)
  buffer_load_dwordx4 v[84:87], v3, s[32:35], s46 offen offset:1280
  s_waitcnt vmcnt(1)
  buffer_load_dwordx4 v[88:91], v3, s[32:35], s46 offen offset:1536
  s_waitcnt vmcnt(1)
  buffer_load_dwordx4 v[92:95], v3, s[32:35], s46 offen offset:1792
  s_waitcnt vmcnt(1)
  buffer_load_dwordx4 v[96:99], v3, s[32:35], s46 offen offset:2048
  s_add_u32 s46, s46, 9216
  v_and_b32 v24, v16, v228
  v_and_b32 v25, v16, v229
  v_and_b32 v26, v16, v230
  v_and_b32 v27, v16, v231
  v_and_b32 v28, v16, v232
  v_and_b32 v29, v16, v233
  v_and_b32 v30, v16, v234
  v_and_b32 v31, v16, v235
  v_and_b32 v32, v16, v4
  v_and_b32 v33, v16, v5
  v_and_b32 v34, v16, v6
  v_and_b32 v35, v16, v7
  s_waitcnt vmcnt(0)
  s_nop 0
  v_mfma_f32_16x16x32_bf16 v[208:211], v[24:27], v[64:67], 0
  v_mfma_f32_16x16x32_bf16 v[212:215], v[24:27], v[68:71], 0
  v_mfma_f32_16x16x32_bf16 v[216:219], v[24:27], v[72:75], 0
  v_mfma_f32_16x16x32_bf16 v[220:223], v[24:27], v[76:79], 0
  v_mfma_f32_16x16x32_bf16 v[224:227], v[32:35], v[80:83], 0
  v_mfma_f32_16x16x32_bf16 v[208:211], v[28:31], v[84:87], v[208:211]
  v_mfma_f32_16x16x32_bf16 v[212:215], v[28:31], v[88:91], v[212:215]
  v_mfma_f32_16x16x32_bf16 v[216:219], v[28:31], v[92:95], v[216:219]
  v_mfma_f32_16x16x32_bf16 v[220:223], v[28:31], v[96:99], v[220:223]
  s_waitcnt vmcnt(1)
  buffer_load_dwordx4 v[100:103], v3, s[32:35], s46 offen offset:0
  s_waitcnt vmcnt(1)
  buffer_load_dwordx4 v[104:107], v3, s[32:35], s46 offen offset:256
  s_waitcnt vmcnt(1)
  buffer_load_dwordx4 v[108:111], v3, s[32:35], s46 offen offset:512
  s_waitcnt vmcnt(1)
  buffer_load_dwordx4 v[112:115], v3, s[32:35], s46 offen offset:768
  s_waitcnt vmcnt(1)
  buffer_load_dwordx4 v[116:119], v3, s[32:35], s46 offen offset:1024
  s_waitcnt vmcnt(1)
  buffer_load_dwordx4 v[120:123], v3, s[32:35], s46 offen offset:1280
  s_waitcnt vmcnt(1)
  buffer_load_dwordx4 v[124:127], v3, s[32:35], s46 offen offset:1536
  s_waitcnt vmcnt(1)
  buffer_load_dwordx4 v[128:131], v3, s[32:35], s46 offen offset:1792
  s_waitcnt vmcnt(1)
  buffer_load_dwordx4 v[132:135], v3, s[32:35], s46 offen offset:2048
  s_add_u32 s46, s46, 9216
  v_and_b32 v24, v17, v228
  v_and_b32 v25, v17, v229
  v_and_b32 v26, v17, v230
  v_and_b32 v27, v17, v231
  v_and_b32 v28, v17, v232
  v_and_b32 v29, v17, v233
  v_and_b32 v30, v17, v234
  v_and_b32 v31, v17, v235
  v_and_b32 v32, v17, v4
  v_and_b32 v33, v17, v5
  v_and_b32 v34, v17, v6
  v_and_b32 v35, v17, v7
  s_waitcnt vmcnt(0)
  s_nop 0
  v_mfma_f32_16x16x32_bf16 v[208:211], v[24:27], v[100:103], v[208:211]
  v_mfma_f32_16x16x32_bf16 v[212:215], v[24:27], v[104:107], v[212:215]
  v_mfma_f32_16x16x32_bf16 v[216:219], v[24:27], v[108:111], v[216:219]
  v_mfma_f32_16x16x32_bf16 v[220:223], v[24:27], v[112:115], v[220:223]
  v_mfma_f32_16x16x32_bf16 v[224:227], v[32:35], v[116:119], v[224:227]
  v_mfma_f32_16x16x32_bf16 v[208:211], v[28:31], v[120:123], v[208:211]
  v_mfma_f32_16x16x32_bf16 v[212:215], v[28:31], v[124:127], v[212:215]
  v_mfma_f32_16x16x32_bf16 v[216:219], v[28:31], v[128:131], v[216:219]
  v_mfma_f32_16x16x32_bf16 v[220:223], v[28:31], v[132:135], v[220:223]
  s_waitcnt vmcnt(1)
  buffer_load_dwordx4 v[64:67], v3, s[32:35], s46 offen offset:0
  s_waitcnt vmcnt(1)
  buffer_load_dwordx4 v[68:71], v3, s[32:35], s46 offen offset:256
  s_waitcnt vmcnt(1)
  buffer_load_dwordx4 v[72:75], v3, s[32:35], s46 offen offset:512
  s_waitcnt vmcnt(1)
  buffer_load_dwordx4 v[76:79], v3, s[32:35], s46 offen offset:768
  s_waitcnt vmcnt(1)
  buffer_load_dwordx4 v[80:83], v3, s[32:35], s46 offen offset:1024
  s_waitcnt vmcnt(1)
  buffer_load_dwordx4 v[84:87], v3, s[32:35], s46 offen offset:1280
  s_waitcnt vmcnt(1)
  buffer_load_dwordx4 v[88:91], v3, s[32:35], s46 offen offset:1536
  s_waitcnt vmcnt(1)
  buffer_load_dwordx4 v[92:95], v3, s[32:35], s46 offen offset:1792
  s_waitcnt vmcnt(1)
  buffer_load_dwordx4 v[96:99], v3, s[32:35], s46 offen offset:2048
  s_add_u32 s46, s46, 9216
  v_and_b32 v24, v18, v228
  v_and_b32 v25, v18, v229
  v_and_b32 v26, v18, v230
  v_and_b32 v27, v18, v231
  v_and_b32 v28, v18, v232
  v_and_b32 v29, v18, v233
  v_and_b32 v30, v18, v234
  v_and_b32 v31, v18, v235
  v_and_b32 v32, v18, v4
  v_and_b32 v33, v18, v5
  v_and_b32 v34, v18, v6
  v_and_b32 v35, v18, v7
  s_waitcnt vmcnt(0)
  s_nop 0
  v_mfma_f32_16x16x32_bf16 v[208:211], v[24:27], v[64:67], v[208:211]
  v_mfma_f32_16x16x32_bf16 v[212:215], v[24:27], v[68:71], v[212:215]
  v_mfma_f32_16x16x32_bf16 v[216:219], v[24:27], v[72:75], v[216:219]
  v_mfma_f32_16x16x32_bf16 v[220:223], v[24:27], v[76:79], v[220:223]
  v_mfma_f32_16x16x32_bf16 v[224:227], v[32:35], v[80:83], v[224:227]
  v_mfma_f32_16x16x32_bf16 v[208:211], v[28:31], v[84:87], v[208:211]
  v_mfma_f32_16x16x32_bf16 v[212:215], v[28:31], v[88:91], v[212:215]
  v_mfma_f32_16x16x32_bf16 v[216:219], v[28:31], v[92:95], v[216:219]
  v_mfma_f32_16x16x32_bf16 v[220:223], v[28:31], v[96:99], v[220:223]
  s_waitcnt vmcnt(1)
  buffer_load_dwordx4 v[100:103], v3, s[32:35], s46 offen offset:0
  s_waitcnt vmcnt(1)
  buffer_load_dwordx4 v[104:107], v3, s[32:35], s46 offen offset:256
  s_waitcnt vmcnt(1)
  buffer_load_dwordx4 v[108:111], v3, s[32:35], s46 offen offset:512
  s_waitcnt vmcnt(1)
  buffer_load_dwordx4 v[112:115], v3, s[32:35], s46 offen offset:768
  s_waitcnt vmcnt(1)
  buffer_load_dwordx4 v[116:119], v3, s[32:35], s46 offen offset:1024
  s_waitcnt vmcnt(1)
  buffer_load_dwordx4 v[120:123], v3, s[32:35], s46 offen offset:1280
  s_waitcnt vmcnt(1)
  buffer_load_dwordx4 v[124:127], v3, s[32:35], s46 offen offset:1536
  s_waitcnt vmcnt(1)
  buffer_load_dwordx4 v[128:131], v3, s[32:35], s46 offen offset:1792
  s_waitcnt vmcnt(1)
  buffer_load_dwordx4 v[132:135], v3, s[32:35], s46 offen offset:2048
  s_add_u32 s46, s46, 9216
  v_and_b32 v24, v19, v228
  v_and_b32 v25, v19, v229
  v_and_b32 v26, v19, v230
  v_and_b32 v27, v19, v231
  v_and_b32 v28, v19, v232
  v_and_b32 v29, v19, v233
  v_and_b32 v30, v19, v234
  v_and_b32 v31, v19, v235
  v_and_b32 v32, v19, v4
  v_and_b32 v33, v19, v5
  v_and_b32 v34, v19, v6
  v_and_b32 v35, v19, v7
  s_waitcnt vmcnt(0)
  s_nop 0
  v_mfma_f32_16x16x32_bf16 v[208:211], v[24:27], v[100:103], v[208:211]
  v_mfma_f32_16x16x32_bf16 v[212:215], v[24:27], v[104:107], v[212:215]
  v_mfma_f32_16x16x32_bf16 v[216:219], v[24:27], v[108:111], v[216:219]
  v_mfma_f32_16x16x32_bf16 v[220:223], v[24:27], v[112:115], v[220:223]
  v_mfma_f32_16x16x32_bf16 v[224:227], v[32:35], v[116:119], v[224:227]
  v_mfma_f32_16x16x32_bf16 v[208:211], v[28:31], v[120:123], v[208:211]
  v_mfma_f32_16x16x32_bf16 v[212:215], v[28:31], v[124:127], v[212:215]
  v_mfma_f32_16x16x32_bf16 v[216:219], v[28:31], v[128:131], v[216:219]
  v_mfma_f32_16x16x32_bf16 v[220:223], v[28:31], v[132:135], v[220:223]
  s_cmp_ge_u32 s44, 2
  s_cbranch_scc1 L_f2_done
  s_waitcnt vmcnt(1)
  buffer_load_dwordx4 v[64:67], v3, s[32:35], s46 offen offset:0
  s_waitcnt vmcnt(1)
  buffer_load_dwordx4 v[68:71], v3, s[32:35], s46 offen offset:256
  s_waitcnt vmcnt(1)
  buffer_load_dwordx4 v[72:75], v3, s[32:35], s46 offen offset:512
  s_waitcnt vmcnt(1)
  buffer_load_dwordx4 v[76:79], v3, s[32:35], s46 offen offset:768
  s_waitcnt vmcnt(1)
  buffer_load_dwordx4 v[80:83], v3, s[32:35], s46 offen offset:1024
  s_waitcnt vmcnt(1)
  buffer_load_dwordx4 v[84:87], v3, s[32:35], s46 offen offset:1280
  s_waitcnt vmcnt(1)
  buffer_load_dwordx4 v[88:91], v3, s[32:35], s46 offen offset:1536
  s_waitcnt vmcnt(1)
  buffer_load_dwordx4 v[92:95], v3, s[32:35], s46 offen offset:1792
  s_waitcnt vmcnt(1)
  buffer_load_dwordx4 v[96:99], v3, s[32:35], s46 offen offset:2048
  s_add_u32 s46, s46, 9216
  v_and_b32 v24, v20, v228
  v_and_b32 v25, v20, v229
  v_and_b32 v26, v20, v230
  v_and_b32 v27, v20, v231
  v_and_b32 v28, v20, v232
  v_and_b32 v29, v20, v233
  v_and_b32 v30, v20, v234
  v_and_b32 v31, v20, v235
  v_and_b32 v32, v20, v4
  v_and_b32 v33, v20, v5
  v_and_b32 v34, v20, v6
  v_and_b32 v35, v20, v7
  s_waitcnt vmcnt(0)
  s_nop 0
  v_mfma_f32_16x16x32_bf16 v[208:211], v[24:27], v[64:67], v[208:211]
  v_mfma_f32_16x16x32_bf16 v[212:215], v[24:27], v[68:71], v[212:215]
  v_mfma_f32_16x16x32_bf16 v[216:219], v[24:27], v[72:75], v[216:219]
  v_mfma_f32_16x16x32_bf16 v[220:223], v[24:27], v[76:79], v[220:223]
  v_mfma_f32_16x16x32_bf16 v[224:227], v[32:35], v[80:83], v[224:227]
  v_mfma_f32_16x16x32_bf16 v[208:211], v[28:31], v[84:87], v[208:211]
  v_mfma_f32_16x16x32_bf16 v[212:215], v[28:31], v[88:91], v[212:215]
  v_mfma_f32_16x16x32_bf16 v[216:219], v[28:31], v[92:95], v[216:219]
  v_mfma_f32_16x16x32_bf16 v[220:223], v[28:31], v[96:99], v[220:223]
L_f2_done:
  s_mov_b32 s32, s12
  s_and_b32 s33, s13, 0xffff
  s_mov_b32 s34, 4718592
  s_mov_b32 s35, 0x20000
  s_mul_i32 s46, s31, 147456
  s_mul_i32 s47, s44, 36864
  s_add_u32 s46, s46, s47
  s_waitcnt vmcnt(1)
  buffer_load_dwordx4 v[64:67], v3, s[32:35], s46 offen offset:0
  s_waitcnt vmcnt(1)
  buffer_load_dwordx4 v[72:75], v3, s[32:35], s46 offen offset:256
  s_waitcnt vmcnt(1)
  buffer_load_dwordx4 v[80:83], v3, s[32:35], s46 offen offset:512
  s_waitcnt vmcnt(1)
  buffer_load_dwordx4 v[88:91], v3, s[32:35], s46 offen offset:768
  s_waitcnt vmcnt(1)
  buffer_load_dwordx4 v[96:99], v3, s[32:35], s46 offen offset:1024
  s_waitcnt vmcnt(1)
  buffer_load_dwordx4 v[104:107], v3, s[32:35], s46 offen offset:1280
  s_waitcnt vmcnt(1)
  buffer_load_dwordx4 v[112:115], v3, s[32:35], s46 offen offset:1536
  s_waitcnt vmcnt(1)
  buffer_load_dwordx4 v[120:123], v3, s[32:35], s46 offen offset:1792
  s_waitcnt vmcnt(1)
  buffer_load_dwordx4 v[128:131], v3, s[32:35], s46 offen offset:2048
  s_add_u32 s46, s46, 9216
  s_waitcnt vmcnt(1)
  buffer_load_dwordx4 v[68:71], v3, s[32:35], s46 offen offset:0
  s_waitcnt vmcnt(1)
  buffer_load_dwordx4 v[76:79], v3, s[32:35], s46 offen offset:256
  s_waitcnt vmcnt(1)
  buffer_load_dwordx4 v[84:87], v3, s[32:35], s46 offen offset:512
  s_waitcnt vmcnt(1)
  buffer_load_dwordx4 v[92:95], v3, s[32:35], s46 offen offset:768
  s_waitcnt vmcnt(1)
  buffer_load_dwordx4 v[100:103], v3, s[32:35], s46 offen offset:1024
  s_waitcnt vmcnt(1)
  buffer_load_dwordx4 v[108:111], v3, s[32:35], s46 offen offset:1280
  s_waitcnt vmcnt(1)
  buffer_load_dwordx4 v[116:119], v3, s[32:35], s46 offen offset:1536
  s_waitcnt vmcnt(1)
  buffer_load_dwordx4 v[124:127], v3, s[32:35], s46 offen offset:1792
  s_waitcnt vmcnt(1)
  buffer_load_dwordx4 v[132:135], v3, s[32:35], s46 offen offset:2048
  s_add_u32 s46, s46, 9216
  s_waitcnt vmcnt(1)
  buffer_load_dwordx4 v[136:139], v3, s[32:35], s46 offen offset:0
  s_waitcnt vmcnt(1)
  buffer_load_dwordx4 v[144:147], v3, s[32:35], s46 offen offset:256
  s_waitcnt vmcnt(1)
  buffer_load_dwordx4 v[152:155], v3, s[32:35], s46 offen offset:512
  s_waitcnt vmcnt(1)
  buffer_load_dwordx4 v[160:163], v3, s[32:35], s46 offen offset:768
  s_waitcnt vmcnt(1)
  buffer_load_dwordx4 v[168:171], v3, s[32:35], s46 offen offset:1024
  s_waitcnt vmcnt(1)
  buffer_load_dwordx4 v[176:179], v3, s[32:35], s46 offen offset:1280
  s_waitcnt vmcnt(1)
  buffer_load_dwordx4 v[184:187], v3, s[32:35], s46 offen offset:1536
  s_waitcnt vmcnt(1)
  buffer_load_dwordx4 v[192:195], v3, s[32:35], s46 offen offset:1792
  s_waitcnt vmcnt(1)
  buffer_load_dwordx4 v[200:203], v3, s[32:35], s46 offen offset:2048
  s_add_u32 s46, s46, 9216
  s_waitcnt vmcnt(1)
  buffer_load_dwordx4 v[140:143], v3, s[32:35], s46 offen offset:0
  s_waitcnt vmcnt(1)
  buffer_load_dwordx4 v[148:151], v3, s[32:35], s46 offen offset:256
  s_waitcnt vmcnt(1)
  buffer_load_dwordx4 v[156:159], v3, s[32:35], s46 offen offset:512
  s_waitcnt vmcnt(1)
  buffer_load_dwordx4 v[164:167], v3, s[32:35], s46 offen offset:768
  s_waitcnt vmcnt(1)
  buffer_load_dwordx4 v[172:175], v3, s[32:35], s46 offen offset:1024
  s_waitcnt vmcnt(1)
  buffer_load_dwordx4 v[180:183], v3, s[32:35], s46 offen offset:1280
  s_waitcnt vmcnt(1)
  buffer_load_dwordx4 v[188:191], v3, s[32:35], s46 offen offset:1536
  s_waitcnt vmcnt(1)
  buffer_load_dwordx4 v[196:199], v3, s[32:35], s46 offen offset:1792
  s_waitcnt vmcnt(1)
  buffer_load_dwordx4 v[204:207], v3, s[32:35], s46 offen offset:2048
  v_and_b32 v13, 4, v0
  v_cmp_eq_u32 vcc, 0, v13
  v_mov_b32 v13, 0xffff
  s_nop 0
  v_cndmask_b32 v4, 0, v13, vcc
  v_cndmask_b32 v5, v13, 0, vcc
  v_and_b32 v13, 3, v0
  v_xor_b32 v6, 1, v13
  v_lshl_or_b32 v6, v6, 2, v13
  s_mov_b32 s43, 0x11111111
  v_mul_lo_u32 v6, v6, s43
  v_and_b32 v13, 8, v0
  v_cmp_eq_u32 vcc, 0, v13
  s_nop 1
  v_cndmask_b32 v228, 0, v4, vcc
  v_cndmask_b32 v232, v4, 0, vcc
  v_cndmask_b32 v229, 0, v5, vcc
  v_cndmask_b32 v233, v5, 0, vcc
  v_lshrrev_b32 v45, 3, v0
  v_lshlrev_b32 v45, 4, v45
  s_lshl_b32 s45, s44, 7
  s_add_u32 s45, s45, 123136
  v_add_u32 v45, s45, v45
  v_mov_b32 v46, 123648
  s_mul_i32 s45, s44, 4608
  v_add_u32 v47, s45, v12
  v_lshrrev_b32 v13, 5, v0
  v_mul_u32_u24 v13, 2560, v13
  v_add_u32 v54, v47, v13
  s_lshl_b32 s45, s44, 8
  v_lshl_add_u32 v48, v0, 2, s45
  v_lshrrev_b32 v13, 5, v48
  v_mul_u32_u24 v13, 7, v13
  v_and_b32 v49, 7, v0
  v_cmp_eq_u32 s[58:59], 7, v49
  v_add_u32 v13, v13, v49
  v_lshlrev_b32 v55, 1, v13
  v_lshlrev_b32 v40, 2, v13
  v_add_u32 v41, 896, v40
  v_add_u32 v42, 1792, v40
  v_mov_b32 v49, 128
  v_cmp_gt_u32 s[60:61], v49, v13
  v_mov_b32 v49, 608
  v_cmp_gt_u32 s[62:63], v49, v48
  s_andn2_b64 s[60:61], s[60:61], s[58:59]
  s_and_b64 s[64:65], s[62:63], s[58:59]
  s_mov_b32 s36, s28
  s_and_b32 s37, s29, 0xffff
  s_mov_b32 s38, 22528
  s_mov_b32 s39, 0x20000
  s_mov_b32 s48, s24
  s_and_b32 s49, s25, 0xffff
  s_mov_b32 s50, 9216
  s_mov_b32 s51, 0x20000
  s_mul_i32 s46, s30, 2688
  s_mul_i32 s54, s30, 1152
  s_waitcnt vmcnt(0)
L_a_w1:
  ds_read_b32 v13, v14 offset:0
  s_waitcnt lgkmcnt(0)
  v_readfirstlane_b32 s45, v13
  s_cmp_ge_u32 s45, 500
  s_cbranch_scc1 L_a_w1_ok
  s_sleep 16
  s_branch L_a_w1
L_a_w1_ok:
L_a_w1b:
  ds_read_b32 v13, v14 offset:0
  s_waitcnt lgkmcnt(0)
  v_readfirstlane_b32 s45, v13
  s_cmp_ge_u32 s45, 510
  s_cbranch_scc1 L_a_w1b_ok
  s_sleep 1
  s_branch L_a_w1b
L_a_w1b_ok:
L_a_w2:
  ds_read_b32 v13, v14 offset:48
  ds_read2st64_b32 v[50:51], v46 offset0:0 offset1:4
  ds_read_b128 v[56:59], v45
  ds_read_b128 v[60:63], v45 offset:1024
  s_waitcnt lgkmcnt(3)
  v_readfirstlane_b32 s45, v13
  s_cmp_ge_u32 s45, 2
  s_cbranch_scc1 L_a_w2_ok
  s_branch L_a_w2
L_a_w2_ok:
  s_waitcnt lgkmcnt(2)
  v_add_f32 v50, v50, v51
  v_rcp_f32 v50, v50
  s_waitcnt lgkmcnt(0)
  v_add_f32 v56, v56, v60
  v_add_f32 v57, v57, v61
  v_add_f32 v58, v58, v62
  v_add_f32 v59, v59, v63
  v_mul_f32 v50, v44, v50
  v_mul_f32 v56, v50, v56
  v_mul_f32 v57, v50, v57
  v_mul_f32 v58, v50, v58
  v_mul_f32 v59, v50, v59
  v_cvt_pk_bf16_f32 v56, v56, v56
  v_cvt_pk_bf16_f32 v57, v57, v57
  v_cvt_pk_bf16_f32 v58, v58, v58
  v_cvt_pk_bf16_f32 v59, v59, v59
  v_and_b32 v16, v56, v228
  v_and_b32 v17, v56, v229
  v_and_b32 v18, v57, v228
  v_and_b32 v19, v57, v229
  s_nop 1
  v_smfmac_f32_16x16x64_bf16 v[208:211], v[16:19], v[64:71], v6
  v_and_b32 v20, v56, v232
  v_and_b32 v21, v56, v233
  v_and_b32 v22, v57, v232
  v_smfmac_f32_16x16x64_bf16 v[212:215], v[16:19], v[72:79], v6
  v_and_b32 v23, v57, v233
  v_and_b32 v24, v56, v4
  v_and_b32 v25, v56, v5
  v_smfmac_f32_16x16x64_bf16 v[216:219], v[16:19], v[80:87], v6
  v_and_b32 v26, v57, v4
  v_and_b32 v27, v57, v5
  v_and_b32 v28, v58, v228
  v_smfmac_f32_16x16x64_bf16 v[220:223], v[16:19], v[88:95], v6
  v_and_b32 v29, v58, v229
  v_and_b32 v30, v59, v228
  v_and_b32 v31, v59, v229
  v_smfmac_f32_16x16x64_bf16 v[208:211], v[20:23], v[104:111], v6
  v_and_b32 v32, v58, v232
  v_and_b32 v33, v58, v233
  v_smfmac_f32_16x16x64_bf16 v[212:215], v[20:23], v[112:119], v6
  v_and_b32 v34, v59, v232
  v_and_b32 v35, v59, v233
  v_smfmac_f32_16x16x64_bf16 v[216:219], v[20:23], v[120:127], v6
  v_and_b32 v36, v58, v4
  v_and_b32 v37, v58, v5
  v_smfmac_f32_16x16x64_bf16 v[220:223], v[20:23], v[128:135], v6
  v_and_b32 v38, v59, v4
  v_and_b32 v39, v59, v5
  v_smfmac_f32_16x16x64_bf16 v[224:227], v[24:27], v[96:103], v6
  v_smfmac_f32_16x16x64_bf16 v[208:211], v[28:31], v[136:143], v6
  v_smfmac_f32_16x16x64_bf16 v[208:211], v[32:35], v[176:183], v6
  v_smfmac_f32_16x16x64_bf16 v[212:215], v[28:31], v[144:151], v6
  v_smfmac_f32_16x16x64_bf16 v[212:215], v[32:35], v[184:191], v6
  v_smfmac_f32_16x16x64_bf16 v[216:219], v[28:31], v[152:159], v6
  v_smfmac_f32_16x16x64_bf16 v[216:219], v[32:35], v[192:199], v6
  s_nop 3
  ds_write_b128 v54, v[208:211] offset:0
  v_smfmac_f32_16x16x64_bf16 v[220:223], v[28:31], v[160:167], v6
  v_smfmac_f32_16x16x64_bf16 v[220:223], v[32:35], v[200:207], v6
  ds_write_b128 v54, v[212:215] offset:512
  v_smfmac_f32_16x16x64_bf16 v[224:227], v[36:39], v[168:175], v6
  s_nop 3
  ds_write_b128 v54, v[216:219] offset:1024
  s_nop 0
  ds_write_b128 v54, v[220:223] offset:1536
  s_mov_b32 exec_lo, 0x00ff00ff
  s_mov_b32 exec_hi, 0xff00ff00
  ds_write_b128 v47, v[224:227] offset:2048
  s_mov_b64 exec, -1
  s_waitcnt lgkmcnt(0)
  s_barrier
  ds_read2st64_b32 v[64:65], v40 offset0:0 offset1:9
  ds_read2st64_b32 v[66:67], v40 offset0:18 offset1:27
  ds_read2st64_b32 v[68:69], v40 offset0:36 offset1:45
  ds_read2st64_b32 v[70:71], v40 offset0:54 offset1:63
  ds_read2st64_b32 v[72:73], v41 offset0:0 offset1:9
  ds_read2st64_b32 v[74:75], v41 offset0:18 offset1:27
  ds_read2st64_b32 v[76:77], v41 offset0:36 offset1:45
  ds_read2st64_b32 v[78:79], v41 offset0:54 offset1:63
  ds_read2st64_b32 v[80:81], v42 offset0:0 offset1:9
  ds_read2st64_b32 v[82:83], v42 offset0:18 offset1:27
  ds_read2st64_b32 v[84:85], v42 offset0:36 offset1:45
  ds_read2st64_b32 v[86:87], v42 offset0:54 offset1:63
  s_waitcnt lgkmcnt(8)
  v_add_f32 v64, v64, v65
  v_add_f32 v66, v66, v67
  v_add_f32 v68, v68, v69
  v_add_f32 v70, v70, v71
  v_add_f32 v64, v64, v66
  v_add_f32 v68, v68, v70
  v_add_f32 v64, v64, v68
  v_cndmask_b32 v88, v64, 1.0, s[58:59]
  buffer_atomic_add_f32 v88, v48, s[36:39], s46 offen offset:0 sc0
  s_waitcnt lgkmcnt(4)
  v_add_f32 v72, v72, v73
  v_add_f32 v74, v74, v75
  v_add_f32 v76, v76, v77
  v_add_f32 v78, v78, v79
  v_add_f32 v72, v72, v74
  v_add_f32 v76, v76, v78
  v_add_f32 v72, v72, v76
  v_cndmask_b32 v89, v72, 1.0, s[58:59]
  buffer_atomic_add_f32 v89, v48, s[36:39], s46 offen offset:1024 sc0
  s_waitcnt lgkmcnt(0)
  v_add_f32 v80, v80, v81
  v_add_f32 v82, v82, v83
  v_add_f32 v84, v84, v85
  v_add_f32 v86, v86, v87
  v_add_f32 v80, v80, v82
  v_add_f32 v84, v84, v86
  v_add_f32 v80, v80, v84
  v_cndmask_b32 v80, 0, v80, s[60:61]
  v_cndmask_b32 v90, v80, 1.0, s[58:59]
  s_mov_b64 exec, s[62:63]
  s_cbranch_execz L_a_two
  buffer_atomic_add_f32 v90, v48, s[36:39], s46 offen offset:2048 sc0
L_a_two:
  s_mov_b64 exec, -1
  s_waitcnt vmcnt(0)
  v_cmp_eq_f32 vcc, 0x41f80000, v88
  v_add_f32 v64, v64, v88
  s_and_b64 s[56:57], vcc, s[58:59]
  s_cbranch_scc0 L_a_skip0
  s_lshr_b64 s[56:57], s[56:57], 7
  v_cvt_pk_bf16_f32 v64, v64, v64
  s_mul_i32 s56, s56, 0x7f
  s_mul_i32 s57, s57, 0x7f
  s_mov_b64 exec, s[56:57]
  buffer_store_short v64, v55, s[48:51], s54 offen offset:0
  s_mov_b64 exec, -1
L_a_skip0:
  v_cmp_eq_f32 vcc, 0x41f80000, v89
  v_add_f32 v72, v72, v89
  s_and_b64 s[56:57], vcc, s[58:59]
  s_cbranch_scc0 L_a_skip1
  s_lshr_b64 s[56:57], s[56:57], 7
  v_cvt_pk_bf16_f32 v72, v72, v72
  s_mul_i32 s56, s56, 0x7f
  s_mul_i32 s57, s57, 0x7f
  s_mov_b64 exec, s[56:57]
  buffer_store_short v72, v55, s[48:51], s54 offen offset:448
  s_mov_b64 exec, -1
L_a_skip1:
  v_cmp_eq_f32 vcc, 0x41f80000, v90
  v_add_f32 v80, v80, v90
  s_and_b64 s[56:57], vcc, s[64:65]
  s_cbranch_scc0 L_a_skip2
  s_lshr_b64 s[56:57], s[56:57], 7
  v_cvt_pk_bf16_f32 v80, v80, v80
  s_mul_i32 s56, s56, 0x7f
  s_mul_i32 s57, s57, 0x7f
  s_and_b64 exec, s[56:57], s[60:61]
  buffer_store_short v80, v55, s[48:51], s54 offen offset:896
  s_mov_b64 exec, -1
L_a_skip2:
L_a_end:
  s_endpgm
L_cons:
  s_setprio 2
  v_and_b32 v8, 4, v0
  v_cmp_eq_u32 vcc, 0, v8
  v_mov_b32 v8, 0xffff
  s_nop 0
  v_cndmask_b32 v4, 0, v8, vcc
  v_cndmask_b32 v5, v8, 0, vcc
  v_and_b32 v8, 3, v0
  v_xor_b32 v6, 1, v8
  v_lshl_or_b32 v6, v6, 2, v8
  s_mov_b32 s43, 0x11111111
  v_mul_lo_u32 v6, v6, s43
  s_sub_u32 s40, s3, 1
  s_mov_b32 s41, 0
  s_lshl_b32 s44, s40, 13
  v_lshlrev_b32 v1, 4, v0
  v_mov_b32 v2, 122880
  s_lshl_b32 s42, s40, 2
  s_add_u32 s42, s42, 122896
  v_mov_b32 v3, s42
  v_mov_b32 v8, 0x3e0293ee
  v_mov_b32 v9, 0xff61b1e6
  v_mov_b32 v10, 0
  v_mov_b32 v36, 0
  v_mov_b32 v100, 0
  v_mov_b32 v37, 0
  v_mov_b32 v101, 0
  v_mov_b32 v38, 0
  v_mov_b32 v102, 0
  v_mov_b32 v39, 0
  v_mov_b32 v103, 0
  v_lshrrev_b32 v11, 4, v0
  v_lshlrev_b32 v11, 2, v11
  v_and_b32 v12, 3, v0
  v_add_u32 v11, v11, v12
  v_lshlrev_b32 v11, 5, v11
  v_add_u32 v11, 123136, v11
  v_bfe_u32 v12, v0, 2, 2
  s_add_u32 s42, s40, 1
L_cpre0:
  ds_read_b32 v13, v2 offset:0
  s_waitcnt lgkmcnt(0)
  v_readfirstlane_b32 s41, v13
  s_cmp_ge_u32 s41, s42
  s_cbranch_scc1 L_cpre0_ok
  s_sleep 2
  s_branch L_cpre0
L_cpre0_ok:
  v_add_u32 v13, s44, v1
  s_add_u32 s40, s40, 2
  ds_read_b128 v[104:107], v13 offset:0
  ds_read_b128 v[108:111], v13 offset:1024
  ds_read_b128 v[112:115], v13 offset:2048
  ds_read_b128 v[116:119], v13 offset:3072
  ds_read_b128 v[120:123], v13 offset:4096
  ds_read_b128 v[124:127], v13 offset:5120
  ds_read_b128 v[128:131], v13 offset:6144
  ds_read_b128 v[132:135], v13 offset:7168
  v_mov_b32 v14, s40
  s_add_u32 s44, s44, 16384
  s_waitcnt lgkmcnt(0)
  ds_write_b32 v3, v14
  s_add_u32 s42, s40, 1
L_cpre1:
  ds_read_b32 v13, v2 offset:0
  s_waitcnt lgkmcnt(0)
  v_readfirstlane_b32 s41, v13
  s_cmp_ge_u32 s41, s42
  s_cbranch_scc1 L_cpre1_ok
  s_sleep 2
  s_branch L_cpre1
L_cpre1_ok:
  v_add_u32 v13, s44, v1
  s_add_u32 s40, s40, 2
  ds_read_b128 v[136:139], v13 offset:0
  ds_read_b128 v[140:143], v13 offset:1024
  ds_read_b128 v[144:147], v13 offset:2048
  ds_read_b128 v[148:151], v13 offset:3072
  ds_read_b128 v[152:155], v13 offset:4096
  ds_read_b128 v[156:159], v13 offset:5120
  ds_read_b128 v[160:163], v13 offset:6144
  ds_read_b128 v[164:167], v13 offset:7168
  v_mov_b32 v14, s40
  s_add_u32 s44, s44, 16384
  s_waitcnt lgkmcnt(0)
  ds_write_b32 v3, v14
  s_add_u32 s42, s40, 1
L_cpre2:
  ds_read_b32 v13, v2 offset:0
  s_waitcnt lgkmcnt(0)
  v_readfirstlane_b32 s41, v13
  s_cmp_ge_u32 s41, s42
  s_cbranch_scc1 L_cpre2_ok
  s_sleep 2
  s_branch L_cpre2
L_cpre2_ok:
  v_add_u32 v13, s44, v1
  s_add_u32 s40, s40, 2
  ds_read_b128 v[168:171], v13 offset:0
  ds_read_b128 v[172:175], v13 offset:1024
  ds_read_b128 v[176:179], v13 offset:2048
  ds_read_b128 v[180:183], v13 offset:3072
  ds_read_b128 v[184:187], v13 offset:4096
  ds_read_b128 v[188:191], v13 offset:5120
  ds_read_b128 v[192:195], v13 offset:6144
  ds_read_b128 v[196:199], v13 offset:7168
  v_mov_b32 v14, s40
  s_add_u32 s44, s44, 16384
  s_waitcnt lgkmcnt(0)
  ds_write_b32 v3, v14
  s_add_u32 s42, s40, 1
L_cpre3:
  ds_read_b32 v13, v2 offset:0
  s_waitcnt lgkmcnt(0)
  v_readfirstlane_b32 s41, v13
  s_cmp_ge_u32 s41, s42
  s_cbranch_scc1 L_cpre3_ok
  s_sleep 2
  s_branch L_cpre3
L_cpre3_ok:
  v_add_u32 v13, s44, v1
  s_add_u32 s40, s40, 2
  ds_read_b128 v[200:203], v13 offset:0
  ds_read_b128 v[204:207], v13 offset:1024
  ds_read_b128 v[208:211], v13 offset:2048
  ds_read_b128 v[212:215], v13 offset:3072
  ds_read_b128 v[216:219], v13 offset:4096
  ds_read_b128 v[220:223], v13 offset:5120
  ds_read_b128 v[224:227], v13 offset:6144
  ds_read_b128 v[228:231], v13 offset:7168
  v_mov_b32 v14, s40
  s_add_u32 s44, s44, 16384
  s_waitcnt lgkmcnt(0)
  ds_write_b32 v3, v14
L_cq:
  ds_read_b32 v13, v2 offset:32
  s_waitcnt lgkmcnt(0)
  v_readfirstlane_b32 s43, v13
  s_cmp_ge_u32 s43, 4
  s_cbranch_scc1 L_cq_ok
  s_sleep 1
  s_branch L_cq
L_cq_ok:
  ds_read_b128 v[64:67], v11 offset:0
  ds_read_b128 v[68:71], v11 offset:16
  ds_read_b128 v[72:75], v11 offset:512
  ds_read_b128 v[76:79], v11 offset:528
  ds_read_b128 v[80:83], v11 offset:1024
  ds_read_b128 v[84:87], v11 offset:1040
  ds_read_b128 v[88:91], v11 offset:1536
  ds_read_b128 v[92:95], v11 offset:1552
  s_waitcnt lgkmcnt(0)
  v_add_f32 v64, v64, v72
  v_add_f32 v80, v80, v88
  v_add_f32 v65, v65, v73
  v_add_f32 v81, v81, v89
  v_add_f32 v66, v66, v74
  v_add_f32 v82, v82, v90
  v_add_f32 v67, v67, v75
  v_add_f32 v83, v83, v91
  v_add_f32 v68, v68, v76
  v_add_f32 v84, v84, v92
  v_add_f32 v69, v69, v77
  v_add_f32 v85, v85, v93
  v_add_f32 v70, v70, v78
  v_add_f32 v86, v86, v94
  v_add_f32 v71, v71, v79
  v_add_f32 v87, v87, v95
  v_add_f32 v64, v64, v80
  v_add_f32 v65, v65, v81
  v_add_f32 v66, v66, v82
  v_add_f32 v67, v67, v83
  v_add_f32 v68, v68, v84
  v_add_f32 v69, v69, v85
  v_add_f32 v70, v70, v86
  v_add_f32 v71, v71, v87
  v_cvt_pk_bf16_f32 v72, v64, v65
  v_cvt_pk_bf16_f32 v73, v66, v67
  v_cvt_pk_bf16_f32 v74, v68, v69
  v_cvt_pk_bf16_f32 v75, v70, v71
  v_cmp_eq_u32 vcc, 0, v12
  s_nop 1
  v_cndmask_b32 v16, 0, v72, vcc
  v_cndmask_b32 v17, 0, v73, vcc
  v_cndmask_b32 v18, 0, v74, vcc
  v_cndmask_b32 v19, 0, v75, vcc
  v_cmp_eq_u32 vcc, 1, v12
  s_nop 1
  v_cndmask_b32 v20, 0, v72, vcc
  v_cndmask_b32 v21, 0, v73, vcc
  v_cndmask_b32 v22, 0, v74, vcc
  v_cndmask_b32 v23, 0, v75, vcc
  v_cmp_eq_u32 vcc, 2, v12
  s_nop 1
  v_cndmask_b32 v24, 0, v72, vcc
  v_cndmask_b32 v25, 0, v73, vcc
  v_cndmask_b32 v26, 0, v74, vcc
  v_cndmask_b32 v27, 0, v75, vcc
  v_cmp_eq_u32 vcc, 3, v12
  s_nop 1
  v_cndmask_b32 v28, 0, v72, vcc
  v_cndmask_b32 v29, 0, v73, vcc
  v_cndmask_b32 v30, 0, v74, vcc
  v_cndmask_b32 v31, 0, v75, vcc
  v_and_b32 v11, 1, v0
  v_cmp_eq_u32 s[46:47], 1, v11
  v_lshlrev_b32 v11, 4, v11
  v_lshl_add_u32 v11, v12, 2, v11
  v_lshrrev_b32 v13, 4, v0
  v_add_u32 v11, v11, v13
  s_sub_u32 s42, s3, 1
  s_lshl_b32 s42, s42, 7
  s_add_u32 s45, s42, 131072
  v_lshl_add_u32 v11, v11, 2, s45
  v_mfma_f32_16x16x32_bf16 v[32:35], v[104:107], v[16:19], 0
  v_mfma_f32_16x16x32_bf16 v[32:35], v[108:111], v[20:23], v[32:35]
  v_mfma_f32_16x16x32_bf16 v[32:35], v[112:115], v[24:27], v[32:35]
  v_mfma_f32_16x16x32_bf16 v[32:35], v[116:119], v[28:31], v[32:35]
  v_mfma_f32_16x16x32_bf16 v[60:63], v[120:123], v[16:19], 0
  v_mfma_f32_16x16x32_bf16 v[60:63], v[124:127], v[20:23], v[60:63]
  v_mfma_f32_16x16x32_bf16 v[60:63], v[128:131], v[24:27], v[60:63]
  v_mfma_f32_16x16x32_bf16 v[60:63], v[132:135], v[28:31], v[60:63]
  s_nop 0
  s_nop 2
  v_mul_f32_dpp v56, v32, v8 quad_perm:[0,0,0,0] row_mask:0xf bank_mask:0xf
  v_mul_f32_dpp v57, v33, v8 quad_perm:[1,1,1,1] row_mask:0xf bank_mask:0xf
  s_nop 0
  v_fmac_f32_dpp v56, v34, v8 quad_perm:[2,2,2,2] row_mask:0xf bank_mask:0xf
  v_fmac_f32_dpp v57, v35, v8 quad_perm:[3,3,3,3] row_mask:0xf bank_mask:0xf
  v_mul_f32_dpp v58, v60, v8 quad_perm:[0,0,0,0] row_mask:0xf bank_mask:0xf
  v_mul_f32_dpp v59, v61, v8 quad_perm:[1,1,1,1] row_mask:0xf bank_mask:0xf
  v_add_f32 v56, v56, v57
  v_fmac_f32_dpp v58, v62, v8 quad_perm:[2,2,2,2] row_mask:0xf bank_mask:0xf
  v_fmac_f32_dpp v59, v63, v8 quad_perm:[3,3,3,3] row_mask:0xf bank_mask:0xf
  v_add_f32 v58, v58, v59
  v_cndmask_b32 v56, v56, v58, s[46:47]
  ds_write_b32 v11, v56
  v_max_f32 v9, v9, v56
  v_add_u32 v11, 256, v11
  v_mfma_f32_16x16x32_bf16 v[32:35], v[136:139], v[16:19], 0
  v_mfma_f32_16x16x32_bf16 v[32:35], v[140:143], v[20:23], v[32:35]
  v_mfma_f32_16x16x32_bf16 v[32:35], v[144:147], v[24:27], v[32:35]
  v_mfma_f32_16x16x32_bf16 v[32:35], v[148:151], v[28:31], v[32:35]
  v_mfma_f32_16x16x32_bf16 v[60:63], v[152:155], v[16:19], 0
  v_mfma_f32_16x16x32_bf16 v[60:63], v[156:159], v[20:23], v[60:63]
  v_mfma_f32_16x16x32_bf16 v[60:63], v[160:163], v[24:27], v[60:63]
  v_mfma_f32_16x16x32_bf16 v[60:63], v[164:167], v[28:31], v[60:63]
  s_nop 0
  s_nop 2
  v_mul_f32_dpp v56, v32, v8 quad_perm:[0,0,0,0] row_mask:0xf bank_mask:0xf
  v_mul_f32_dpp v57, v33, v8 quad_perm:[1,1,1,1] row_mask:0xf bank_mask:0xf
  s_nop 0
  v_fmac_f32_dpp v56, v34, v8 quad_perm:[2,2,2,2] row_mask:0xf bank_mask:0xf
  v_fmac_f32_dpp v57, v35, v8 quad_perm:[3,3,3,3] row_mask:0xf bank_mask:0xf
  v_mul_f32_dpp v58, v60, v8 quad_perm:[0,0,0,0] row_mask:0xf bank_mask:0xf
  v_mul_f32_dpp v59, v61, v8 quad_perm:[1,1,1,1] row_mask:0xf bank_mask:0xf
  v_add_f32 v56, v56, v57
  v_fmac_f32_dpp v58, v62, v8 quad_perm:[2,2,2,2] row_mask:0xf bank_mask:0xf
  v_fmac_f32_dpp v59, v63, v8 quad_perm:[3,3,3,3] row_mask:0xf bank_mask:0xf
  v_add_f32 v58, v58, v59
  v_cndmask_b32 v56, v56, v58, s[46:47]
  ds_write_b32 v11, v56
  v_max_f32 v9, v9, v56
  v_add_u32 v11, 256, v11
  v_mfma_f32_16x16x32_bf16 v[32:35], v[168:171], v[16:19], 0
  v_mfma_f32_16x16x32_bf16 v[32:35], v[172:175], v[20:23], v[32:35]
  v_mfma_f32_16x16x32_bf16 v[32:35], v[176:179], v[24:27], v[32:35]
  v_mfma_f32_16x16x32_bf16 v[32:35], v[180:183], v[28:31], v[32:35]
  v_mfma_f32_16x16x32_bf16 v[60:63], v[184:187], v[16:19], 0
  v_mfma_f32_16x16x32_bf16 v[60:63], v[188:191], v[20:23], v[60:63]
  v_mfma_f32_16x16x32_bf16 v[60:63], v[192:195], v[24:27], v[60:63]
  v_mfma_f32_16x16x32_bf16 v[60:63], v[196:199], v[28:31], v[60:63]
  s_nop 0
  s_nop 2
  v_mul_f32_dpp v56, v32, v8 quad_perm:[0,0,0,0] row_mask:0xf bank_mask:0xf
  v_mul_f32_dpp v57, v33, v8 quad_perm:[1,1,1,1] row_mask:0xf bank_mask:0xf
  s_nop 0
  v_fmac_f32_dpp v56, v34, v8 quad_perm:[2,2,2,2] row_mask:0xf bank_mask:0xf
  v_fmac_f32_dpp v57, v35, v8 quad_perm:[3,3,3,3] row_mask:0xf bank_mask:0xf
  v_mul_f32_dpp v58, v60, v8 quad_perm:[0,0,0,0] row_mask:0xf bank_mask:0xf
  v_mul_f32_dpp v59, v61, v8 quad_perm:[1,1,1,1] row_mask:0xf bank_mask:0xf
  v_add_f32 v56, v56, v57
  v_fmac_f32_dpp v58, v62, v8 quad_perm:[2,2,2,2] row_mask:0xf bank_mask:0xf
  v_fmac_f32_dpp v59, v63, v8 quad_perm:[3,3,3,3] row_mask:0xf bank_mask:0xf
  v_add_f32 v58, v58, v59
  v_cndmask_b32 v56, v56, v58, s[46:47]
  ds_write_b32 v11, v56
  v_max_f32 v9, v9, v56
  v_add_u32 v11, 256, v11
  v_mfma_f32_16x16x32_bf16 v[32:35], v[200:203], v[16:19], 0
  v_mfma_f32_16x16x32_bf16 v[32:35], v[204:207], v[20:23], v[32:35]
  v_mfma_f32_16x16x32_bf16 v[32:35], v[208:211], v[24:27], v[32:35]
  v_mfma_f32_16x16x32_bf16 v[32:35], v[212:215], v[28:31], v[32:35]
  v_mfma_f32_16x16x32_bf16 v[60:63], v[216:219], v[16:19], 0
  v_mfma_f32_16x16x32_bf16 v[60:63], v[220:223], v[20:23], v[60:63]
  v_mfma_f32_16x16x32_bf16 v[60:63], v[224:227], v[24:27], v[60:63]
  v_mfma_f32_16x16x32_bf16 v[60:63], v[228:231], v[28:31], v[60:63]
  s_nop 0
  s_nop 2
  v_mul_f32_dpp v56, v32, v8 quad_perm:[0,0,0,0] row_mask:0xf bank_mask:0xf
  v_mul_f32_dpp v57, v33, v8 quad_perm:[1,1,1,1] row_mask:0xf bank_mask:0xf
  s_nop 0
  v_fmac_f32_dpp v56, v34, v8 quad_perm:[2,2,2,2] row_mask:0xf bank_mask:0xf
  v_fmac_f32_dpp v57, v35, v8 quad_perm:[3,3,3,3] row_mask:0xf bank_mask:0xf
  v_mul_f32_dpp v58, v60, v8 quad_perm:[0,0,0,0] row_mask:0xf bank_mask:0xf
  v_mul_f32_dpp v59, v61, v8 quad_perm:[1,1,1,1] row_mask:0xf bank_mask:0xf
  v_add_f32 v56, v56, v57
  v_fmac_f32_dpp v58, v62, v8 quad_perm:[2,2,2,2] row_mask:0xf bank_mask:0xf
  v_fmac_f32_dpp v59, v63, v8 quad_perm:[3,3,3,3] row_mask:0xf bank_mask:0xf
  v_add_f32 v58, v58, v59
  v_cndmask_b32 v56, v56, v58, s[46:47]
  ds_write_b32 v11, v56
  v_max_f32 v9, v9, v56
  v_add_u32 v11, 256, v11
L_c0loop:
  s_cmp_lt_u32 s40, s41
  s_cbranch_scc0 L_c0poll
L_c0go:
  v_add_u32 v13, s44, v1
  s_add_u32 s40, s40, 2
  ds_read_b128 v[64:67], v13 offset:0
  ds_read_b128 v[68:71], v13 offset:1024
  ds_read_b128 v[72:75], v13 offset:2048
  ds_read_b128 v[76:79], v13 offset:3072
  ds_read_b128 v[80:83], v13 offset:4096
  ds_read_b128 v[84:87], v13 offset:5120
  ds_read_b128 v[88:91], v13 offset:6144
  ds_read_b128 v[92:95], v13 offset:7168
  v_mov_b32 v14, s40
  s_add_u32 s44, s44, 16384
  s_cmp_ge_u32 s44, 122880
  s_cselect_b32 s42, 122880, 0
  s_sub_u32 s44, s44, s42
  s_waitcnt lgkmcnt(7)
  v_mfma_f32_16x16x32_bf16 v[32:35], v[64:67], v[16:19], 0
  s_waitcnt lgkmcnt(6)
  v_mfma_f32_16x16x32_bf16 v[32:35], v[68:71], v[20:23], v[32:35]
  s_waitcnt lgkmcnt(5)
  v_mfma_f32_16x16x32_bf16 v[32:35], v[72:75], v[24:27], v[32:35]
  s_waitcnt lgkmcnt(4)
  v_mfma_f32_16x16x32_bf16 v[32:35], v[76:79], v[28:31], v[32:35]
  s_waitcnt lgkmcnt(3)
  v_mfma_f32_16x16x32_bf16 v[60:63], v[80:83], v[16:19], 0
  s_waitcnt lgkmcnt(2)
  v_mfma_f32_16x16x32_bf16 v[60:63], v[84:87], v[20:23], v[60:63]
  s_waitcnt lgkmcnt(1)
  v_mfma_f32_16x16x32_bf16 v[60:63], v[88:91], v[24:27], v[60:63]
  s_waitcnt lgkmcnt(0)
  v_mfma_f32_16x16x32_bf16 v[60:63], v[92:95], v[28:31], v[60:63]
  ds_write_b32 v3, v14
  s_nop 2
  v_mul_f32_dpp v56, v32, v8 quad_perm:[0,0,0,0] row_mask:0xf bank_mask:0xf
  v_mul_f32_dpp v57, v33, v8 quad_perm:[1,1,1,1] row_mask:0xf bank_mask:0xf
  s_nop 0
  v_fmac_f32_dpp v56, v34, v8 quad_perm:[2,2,2,2] row_mask:0xf bank_mask:0xf
  v_fmac_f32_dpp v57, v35, v8 quad_perm:[3,3,3,3] row_mask:0xf bank_mask:0xf
  v_mul_f32_dpp v58, v60, v8 quad_perm:[0,0,0,0] row_mask:0xf bank_mask:0xf
  v_mul_f32_dpp v59, v61, v8 quad_perm:[1,1,1,1] row_mask:0xf bank_mask:0xf
  v_add_f32 v56, v56, v57
  v_fmac_f32_dpp v58, v62, v8 quad_perm:[2,2,2,2] row_mask:0xf bank_mask:0xf
  v_fmac_f32_dpp v59, v63, v8 quad_perm:[3,3,3,3] row_mask:0xf bank_mask:0xf
  v_add_f32 v58, v58, v59
  v_cndmask_b32 v56, v56, v58, s[46:47]
  ds_write_b32 v11, v56
  v_max_f32 v9, v9, v56
  v_add_u32 v11, 256, v11
  s_cmp_lt_u32 s40, 256
  s_cbranch_scc1 L_c0loop
  s_nop 1
  v_max_f32_dpp v9, v9, v9 row_ror:1 row_mask:0xf bank_mask:0xf
  s_nop 1
  v_max_f32_dpp v9, v9, v9 row_ror:4 row_mask:0xf bank_mask:0xf
  s_nop 1
  v_max_f32_dpp v9, v9, v9 row_ror:8 row_mask:0xf bank_mask:0xf
  v_mov_b32 v57, v9
  s_nop 1
  v_permlane16_swap_b32 v57, v9
  v_max_f32 v9, v9, v57
  v_mov_b32 v57, v9
  s_nop 1
  v_permlane32_swap_b32 v57, v9
  v_max_f32 v9, v9, v57
  v_mov_b32 v60, 1
  ds_write_b32 v3, v9 offset:36
  s_mov_b64 exec, 1
  ds_add_u32 v2, v60 offset:60
  s_mov_b64 exec, -1
  v_bfe_u32 v11, v0, 1, 2
  v_lshrrev_b32 v13, 4, v0
  v_lshl_add_u32 v11, v11, 2, v13
  v_and_b32 v13, 1, v0
  v_lshl_add_u32 v11, v11, 1, v13
  v_lshl_add_u32 v11, v11, 2, s45
  v_bfe_u32 v12, v0, 2, 2
  v_lshlrev_b32 v12, 7, v12
  v_and_b32 v13, 1, v0
  v_lshl_add_u32 v12, v13, 6, v12
  v_bfe_u32 v13, v0, 4, 1
  v_lshl_add_u32 v12, v13, 5, v12
  v_bfe_u32 v13, v0, 1, 1
  v_lshl_add_u32 v12, v13, 3, v12
  s_sub_u32 s42, s3, 1
  s_lshl_b32 s42, s42, 10
  s_add_u32 s42, s42, 123136
  v_add_u32 v12, s42, v12
  v_mov_b32 v59, s42
L_cmax:
  ds_read_b32 v13, v2 offset:60
  ds_read2_b32 v[56:57], v2 offset0:13 offset1:14
  s_waitcnt lgkmcnt(1)
  v_readfirstlane_b32 s43, v13
  s_cmp_ge_u32 s43, 2
  s_cbranch_scc1 L_cmax_ok
  s_sleep 1
  s_branch L_cmax
L_cmax_ok:
  s_waitcnt lgkmcnt(0)
  v_max_f32 v9, v56, v57
L_c1loop:
  s_cmp_lt_u32 s40, s41
  s_cbranch_scc0 L_c1poll
L_c1go:
  v_add_u32 v13, s44, v1
  s_add_u32 s40, s40, 2
  ds_read_b32 v56, v11
  ds_read_b128 v[64:67], v13 offset:0
  ds_read_b128 v[68:71], v13 offset:1024
  ds_read_b128 v[72:75], v13 offset:2048
  ds_read_b128 v[76:79], v13 offset:3072
  ds_read_b128 v[80:83], v13 offset:4096
  ds_read_b128 v[84:87], v13 offset:5120
  ds_read_b128 v[88:91], v13 offset:6144
  ds_read_b128 v[92:95], v13 offset:7168
  v_mov_b32 v14, s40
  v_add_u32 v11, 256, v11
  s_add_u32 s44, s44, 16384
  s_cmp_ge_u32 s44, 122880
  s_cselect_b32 s42, 122880, 0
  s_sub_u32 s44, s44, s42
  s_waitcnt lgkmcnt(8)
  v_sub_f32 v57, v56, v9
  v_exp_f32 v57, v57
  s_nop 0
  v_cvt_pk_bf16_f32 v58, v57, v57
  v_add_f32 v10, v10, v57
  s_nop 0
  v_and_b32_dpp v40, v58, v4 row_newbcast:0 row_mask:0xf bank_mask:0xf
  v_and_b32_dpp v41, v58, v5 row_newbcast:0 row_mask:0xf bank_mask:0xf
  v_and_b32_dpp v42, v58, v4 row_newbcast:1 row_mask:0xf bank_mask:0xf
  v_and_b32_dpp v43, v58, v5 row_newbcast:1 row_mask:0xf bank_mask:0xf
  v_and_b32_dpp v44, v58, v4 row_newbcast:2 row_mask:0xf bank_mask:0xf
  v_and_b32_dpp v45, v58, v5 row_newbcast:2 row_mask:0xf bank_mask:0xf
  v_and_b32_dpp v46, v58, v4 row_newbcast:3 row_mask:0xf bank_mask:0xf
  v_and_b32_dpp v47, v58, v5 row_newbcast:3 row_mask:0xf bank_mask:0xf
  s_waitcnt lgkmcnt(6)
  v_smfmac_f32_16x16x64_bf16 v[36:39], v[40:43], v[64:71], v6
  v_and_b32_dpp v48, v58, v4 row_newbcast:4 row_mask:0xf bank_mask:0xf
  v_and_b32_dpp v49, v58, v5 row_newbcast:4 row_mask:0xf bank_mask:0xf
  v_and_b32_dpp v50, v58, v4 row_newbcast:5 row_mask:0xf bank_mask:0xf
  v_and_b32_dpp v51, v58, v5 row_newbcast:5 row_mask:0xf bank_mask:0xf
  s_waitcnt lgkmcnt(4)
  v_smfmac_f32_16x16x64_bf16 v[100:103], v[44:47], v[72:79], v6
  v_and_b32_dpp v52, v58, v4 row_newbcast:6 row_mask:0xf bank_mask:0xf
  v_and_b32_dpp v53, v58, v5 row_newbcast:6 row_mask:0xf bank_mask:0xf
  v_and_b32_dpp v54, v58, v4 row_newbcast:7 row_mask:0xf bank_mask:0xf
  v_and_b32_dpp v55, v58, v5 row_newbcast:7 row_mask:0xf bank_mask:0xf
  s_waitcnt lgkmcnt(2)
  v_smfmac_f32_16x16x64_bf16 v[36:39], v[48:51], v[80:87], v6
  s_waitcnt lgkmcnt(0)
  s_nop 0
  v_smfmac_f32_16x16x64_bf16 v[100:103], v[52:55], v[88:95], v6
  ds_write_b32 v3, v14
  s_cmp_lt_u32 s40, 512
  s_cbranch_scc1 L_c1loop
  v_add_f32_dpp v10, v10, v10 row_ror:1 row_mask:0xf bank_mask:0xf
  s_nop 1
  v_add_f32_dpp v10, v10, v10 row_ror:2 row_mask:0xf bank_mask:0xf
  s_nop 1
  v_add_f32_dpp v10, v10, v10 row_ror:4 row_mask:0xf bank_mask:0xf
  s_nop 1
  v_mov_b32 v11, v10
  s_nop 1
  v_permlane16_swap_b32 v11, v10
  v_add_f32 v10, v10, v11
  v_mov_b32 v11, v10
  s_nop 1
  v_permlane32_swap_b32 v11, v10
  v_add_f32 v10, v10, v11
  v_add_f32 v36, v36, v100
  v_add_f32 v37, v37, v101
  v_add_f32 v38, v38, v102
  v_add_f32 v39, v39, v103
  ds_write_b32 v59, v10 offset:512
  ds_write2_b32 v12, v36, v38 offset0:0 offset1:1
  ds_write2_b32 v12, v37, v39 offset0:4 offset1:5
  s_mov_b64 exec, 1
  ds_add_u32 v2, v60 offset:48
  s_mov_b64 exec, -1
  s_waitcnt lgkmcnt(0)
  s_endpgm
L_c0poll:
  ds_read_b32 v13, v2
  s_waitcnt lgkmcnt(0)
  v_readfirstlane_b32 s41, v13
  s_cmp_lt_u32 s40, s41
  s_cbranch_scc1 L_c0go
  s_sleep 1
  s_branch L_c0poll
L_c1poll:
  ds_read_b32 v13, v2
  s_waitcnt lgkmcnt(0)
  v_readfirstlane_b32 s41, v13
  s_cmp_lt_u32 s40, s41
  s_cbranch_scc1 L_c1go
  s_cmp_ge_u32 s40, 506
  s_cbranch_scc1 L_c1poll
  s_sleep 1
  s_branch L_c1poll
L_init:
  v_mov_b32 v3, 122880
  v_lshlrev_b32 v2, 4, v0
  s_waitcnt lgkmcnt(0)
  s_mov_b32 s36, s28
  s_and_b32 s37, s29, 0xffff
  s_mov_b32 s38, 161792
  s_mov_b32 s39, 0x20000
  s_cmp_eq_u32 s2, 255
  s_cbranch_scc1 L_z_claim
  s_lshr_b32 s40, s2, 2
  s_add_u32 s40, s40, 64
L_zwait:
  ds_read_b32 v4, v3 offset:0
  s_waitcnt lgkmcnt(0)
  v_readfirstlane_b32 s45, v4
  s_cmp_ge_u32 s45, s40
  s_cbranch_scc1 L_zwait_ok
  s_sleep 32
  s_branch L_zwait
L_zwait_ok:
  s_load_dword s43, s[26:27], 64
  s_waitcnt lgkmcnt(0)
  s_cmp_lg_u32 s43, 0
  s_cbranch_scc1 L_z_ok
L_z_claim:
  s_mov_b32 s44, 1
  s_atomic_add s44, s[26:27], 0 glc
  s_waitcnt lgkmcnt(0)
  s_cmp_lg_u32 s44, 0
  s_cbranch_scc1 L_z_spin
  v_mov_b32 v4, 0
  v_mov_b32 v5, 0
  v_mov_b32 v6, 0
  v_mov_b32 v7, 0
  v_mul_u32_u24 v8, 4352, v0
  s_mov_b32 s44, 22528
  buffer_store_dwordx4 v[4:7], v8, s[36:39], s44 offen sc1
  buffer_store_dwordx4 v[4:7], v8, s[36:39], s44 offen offset:16 sc1
  s_mov_b32 s44, 0
L_z_loop:
  buffer_store_dwordx4 v[4:7], v2, s[36:39], s44 offen offset:0 sc1
  buffer_store_dwordx4 v[4:7], v2, s[36:39], s44 offen offset:1024 sc1
  s_add_u32 s44, s44, 2048
  s_cmp_lt_u32 s44, 22528
  s_cbranch_scc1 L_z_loop
  s_mov_b32 s44, 1
  s_waitcnt vmcnt(0)
  s_atomic_add s44, s[26:27], 64
  s_waitcnt lgkmcnt(0)
  s_branch L_z_ok
L_z_spin:
  s_sleep 32
  s_mov_b32 s43, 0
  s_atomic_add s43, s[26:27], 64 glc
  s_waitcnt lgkmcnt(0)
  s_cmp_eq_u32 s43, 0
  s_cbranch_scc1 L_z_spin
L_z_ok:
  s_lshr_b32 s54, s2, 3
  s_add_u32 s54, s54, s2
  s_and_b32 s54, s54, 3
  s_mov_b32 s58, s54
  s_mov_b32 s54, 0
  s_lshl_b32 s55, s30, 2
  s_add_u32 s54, s54, s55
  s_mul_i32 s54, s54, 4352
  s_add_u32 s54, s54, 22528
  s_add_u32 s54, s28, s54
  s_addc_u32 s55, s29, 0
L_rkw0:
  ds_read_b32 v4, v3 offset:0
  s_waitcnt lgkmcnt(0)
  v_readfirstlane_b32 s45, v4
  s_cmp_ge_u32 s45, 170
  s_cbranch_scc1 L_rkw0_ok
  s_sleep 4
  s_branch L_rkw0
L_rkw0_ok:
  s_cmp_eq_u32 s58, 0
  s_cbranch_scc1 L_rka0
  s_load_dword s43, s[54:55], 0 glc
  s_branch L_rkb0
L_rka0:
  s_mov_b32 s43, 1
  s_atomic_add s43, s[54:55], 0 glc
L_rkb0:
  s_waitcnt lgkmcnt(0)
  s_cmp_lt_u32 s43, 3
  s_cselect_b32 s44, 2, 0
  s_cmp_ge_u32 s43, 7
  s_cselect_b32 s44, 3, s44
  v_mov_b32 v4, s44
  ds_write_b32 v3, v4 offset:24
L_rkw1:
  ds_read_b32 v4, v3 offset:0
  s_waitcnt lgkmcnt(0)
  v_readfirstlane_b32 s45, v4
  s_cmp_ge_u32 s45, 260
  s_cbranch_scc1 L_rkw1_ok
  s_sleep 4
  s_branch L_rkw1
L_rkw1_ok:
  s_cmp_eq_u32 s58, 0
  s_cbranch_scc1 L_rka1
  s_load_dword s43, s[54:55], 4 glc
  s_branch L_rkb1
L_rka1:
  s_mov_b32 s43, 1
  s_atomic_add s43, s[54:55], 4 glc
L_rkb1:
  s_waitcnt lgkmcnt(0)
  s_cmp_lt_u32 s43, 3
  s_cselect_b32 s44, 2, 0
  s_cmp_ge_u32 s43, 7
  s_cselect_b32 s44, 3, s44
  v_mov_b32 v4, s44
  ds_write_b32 v3, v4 offset:24
L_rkw2:
  ds_read_b32 v4, v3 offset:0
  s_waitcnt lgkmcnt(0)
  v_readfirstlane_b32 s45, v4
  s_cmp_ge_u32 s45, 350
  s_cbranch_scc1 L_rkw2_ok
  s_sleep 4
  s_branch L_rkw2
L_rkw2_ok:
  s_cmp_eq_u32 s58, 0
  s_cbranch_scc1 L_rka2
  s_load_dword s43, s[54:55], 8 glc
  s_branch L_rkb2
L_rka2:
  s_mov_b32 s43, 1
  s_atomic_add s43, s[54:55], 8 glc
L_rkb2:
  s_waitcnt lgkmcnt(0)
  s_cmp_lt_u32 s43, 3
  s_cselect_b32 s44, 2, 0
  s_cmp_ge_u32 s43, 7
  s_cselect_b32 s44, 3, s44
  v_mov_b32 v4, s44
  ds_write_b32 v3, v4 offset:24
L_rkw3:
  ds_read_b32 v4, v3 offset:0
  s_waitcnt lgkmcnt(0)
  v_readfirstlane_b32 s45, v4
  s_cmp_ge_u32 s45, 440
  s_cbranch_scc1 L_rkw3_ok
  s_sleep 4
  s_branch L_rkw3
L_rkw3_ok:
  s_cmp_eq_u32 s58, 0
  s_cbranch_scc1 L_rka3
  s_load_dword s43, s[54:55], 12 glc
  s_branch L_rkb3
L_rka3:
  s_mov_b32 s43, 1
  s_atomic_add s43, s[54:55], 12 glc
L_rkb3:
  s_waitcnt lgkmcnt(0)
  s_cmp_lt_u32 s43, 3
  s_cselect_b32 s44, 2, 0
  s_cmp_ge_u32 s43, 7
  s_cselect_b32 s44, 3, s44
  v_mov_b32 v4, s44
  ds_write_b32 v3, v4 offset:24
L_rkw4:
  ds_read_b32 v4, v3 offset:0
  s_waitcnt lgkmcnt(0)
  v_readfirstlane_b32 s45, v4
  s_cmp_ge_u32 s45, 494
  s_cbranch_scc1 L_rkw4_ok
  s_sleep 2
  s_branch L_rkw4
L_rkw4_ok:
  s_cmp_eq_u32 s58, 0
  s_cbranch_scc1 L_rka4
  s_load_dword s43, s[54:55], 16 glc
  s_branch L_rkb4
L_rka4:
  s_mov_b32 s43, 1
  s_atomic_add s43, s[54:55], 16 glc
L_rkb4:
  s_waitcnt lgkmcnt(0)
  s_cmp_lt_u32 s43, 3
  s_cselect_b32 s44, 4, 0
  s_cmp_ge_u32 s43, 7
  s_cselect_b32 s44, 1, s44
  v_mov_b32 v4, s44
  ds_write_b32 v3, v4 offset:24
  s_waitcnt vmcnt(0) lgkmcnt(0)
L_done:
  s_endpgm
.section .rodata,"a"
.p2align 6
.amdhsa_kernel gated_mix__mha_block_cached__swiglu_ffn__decode_kernel
  .amdhsa_next_free_vgpr 256
  .amdhsa_next_free_sgpr 96
  .amdhsa_accum_offset 256
  .amdhsa_group_segment_fixed_size 0
  .amdhsa_kernarg_size 104
  .amdhsa_user_sgpr_count 2
  .amdhsa_user_sgpr_kernarg_segment_ptr 1
  .amdhsa_system_sgpr_workgroup_id_x 1
.end_amdhsa_kernel
```
